```python
import torch

def _softmax(x, axis=-1):
    return torch.softmax(x, dim=axis)
def _gelu(x):
    return torch.nn.functional.gelu(x, approximate="tanh")
def _silu(x):
    return torch.nn.functional.silu(x)
def _sigmoid(x):
    return torch.sigmoid(x)
def _layernorm(x, axis=-1, eps=1e-5):
    m = x.mean(dim=axis, keepdim=True)
    v = x.var(dim=axis, keepdim=True, unbiased=False)
    return (x - m) / torch.sqrt(v + eps)
def _scatter_add(tgt, idx, src, axis=0):
    return tgt.clone().index_add_(axis, idx, src)
def _segment_sum(src, seg, n):
    out = torch.zeros((n,) + src.shape[1:], dtype=src.dtype)
    return out.index_add_(0, seg, src)
def _pad(x, pw):
    flat = tuple(v for pair in reversed(pw) for v in pair)
    return torch.nn.functional.pad(x, flat)

kernel_name = 'interleave_layers__ssm_conv_s4__sliding_block__prompt'

def setup_inputs():

    _w = (lambda a: (lambda t: t.to(torch.bfloat16) if t.is_floating_point() else t)(torch.as_tensor(a)))
    def _A_setup():
        B, L, D, N = 1, 2048, 512, 128
        A_re = -(lambda _x: torch.exp(torch.as_tensor(_x)))((lambda *s: torch.randn(*s, dtype=torch.bfloat16) * 1.6)(D, N))
        A_im = torch.pi * (lambda *s: torch.randn(*s, dtype=torch.bfloat16) * 0.05)(D, N)
        B_re = (lambda *s: torch.randn(*s, dtype=torch.bfloat16) * 0.05)(D, N)
        B_im = (lambda *s: torch.randn(*s, dtype=torch.bfloat16) * 0.05)(D, N)
        C_re = (lambda *s: torch.randn(*s, dtype=torch.bfloat16) * 0.05)(D, N)
        C_im = (lambda *s: torch.randn(*s, dtype=torch.bfloat16) * 0.05)(D, N)
        log_dt = (lambda *s: torch.randn(*s, dtype=torch.bfloat16) * 0.05)(D) * 0.5 - 4.0
        Dskip = (lambda *s: torch.randn(*s, dtype=torch.bfloat16) * 0.05)(D)
        return {
            "u": _w((lambda *s: torch.randn(*s, dtype=torch.bfloat16) * 0.05)(B, L, D)),
            "A_re": _w(A_re),
            "A_im": _w(A_im),
            "B_re": _w(B_re),
            "B_im": _w(B_im),
            "C_re": _w(C_re),
            "C_im": _w(C_im),
            "log_dt": _w(log_dt),
            "Dskip": _w(Dskip),
        }
    _A_in = _A_setup()

    def _B_setup():
        B, S, D = 1, 2048, 512
        return {
            "x": _w((lambda *s: torch.randn(*s, dtype=torch.bfloat16) * 0.05)(B, S, D)),
            "wqkv": _w((lambda *s: torch.randn(*s, dtype=torch.bfloat16) * 0.05)(D, 3 * D)),
            "wo": _w((lambda *s: torch.randn(*s, dtype=torch.bfloat16) * 0.05)(D, D)),
        }
    _B_in = _B_setup()

    return {
        "A_u": _A_in["u"],
        "A_A_re": _A_in["A_re"],
        "A_A_im": _A_in["A_im"],
        "A_B_re": _A_in["B_re"],
        "A_B_im": _A_in["B_im"],
        "A_C_re": _A_in["C_re"],
        "A_C_im": _A_in["C_im"],
        "A_log_dt": _A_in["log_dt"],
        "A_Dskip": _A_in["Dskip"],
        "B_x": _B_in["x"],
        "B_wqkv": _B_in["wqkv"],
        "B_wo": _B_in["wo"],
    }

def reference(A_u, A_A_re, A_A_im, A_B_re, A_B_im, A_C_re, A_C_im, A_log_dt, A_Dskip, B_x, B_wqkv, B_wo):
    def _A_ref(u, A_re, A_im, B_re, B_im, C_re, C_im, log_dt, Dskip):
        Bsz, L, D = u.shape
        dt = torch.exp(log_dt)[:, None]
        A = A_re + 1j * A_im
        Bc = B_re + 1j * B_im
        Cc = C_re + 1j * C_im
        logdA = dt * A
        dB = dt * Bc
        l = (lambda x, dt: x.to(dt))(torch.arange(L), A_re.dtype)
        P = torch.exp(logdA[:, :, None] * l[None, None, :])
        K = torch.einsum("dn,dnl,dn->dl", Cc, P, dB).real
        L2 = 2 * L
        Kp = _pad(K, ((0, 0), (0, L)))
        up = (lambda x, *d: x.permute(*d))(u, 0, 2, 1)
        up = _pad(up, ((0, 0), (0, 0), (0, L)))
        Kf = (lambda x, axes=(-2,-1): torch.fft.rfft2(x.float(), dim=axes))(Kp[:, None, :], axes=(-2, -1))
        Uf = (lambda x, axes=(-2,-1): torch.fft.rfft2(x.float(), dim=axes))(up[:, :, None, :], axes=(-2, -1))
        Yf = Uf * Kf[None, :, :, :]
        y = (lambda x, s, axes=(-2,-1): torch.fft.irfft2(x, s=s, dim=axes).to(torch.bfloat16))(Yf, (1, L2), axes=(-2, -1))[:, :, 0, :L]
        y = (lambda x, *d: x.permute(*d))(y, 0, 2, 1) + u * Dskip[None, None, :]
        return y

    def _B_ref(x, wqkv, wo):
        B, S, D = x.shape
        H = 32; Dh = D // H; W = 256
        qkv = (lambda x, *d: x.permute(*d))((x @ wqkv).reshape(B, S, 3, H, Dh), 2, 0, 3, 1, 4)
        q, k, v = qkv[0], qkv[1], qkv[2]
        scores = torch.einsum("bhqd,bhkd->bhqk", q, k) * (Dh ** -0.5)
        idx = torch.arange(S)
        mask = (idx[:, None] - idx[None, :] >= 0) & (idx[:, None] - idx[None, :] < W)
        scores = torch.where(mask[None, None], scores, -1e9)
        p = _softmax(scores, axis=-1)
        o = torch.einsum("bhqk,bhkd->bhqd", p, v)
        return (lambda x, *d: x.permute(*d))(o, 0, 2, 1, 3).reshape(B, S, D) @ wo

    x = A_u
    x = x + _A_ref(_layernorm(x, axis=-1), A_A_re, A_A_im, A_B_re, A_B_im, A_C_re, A_C_im, A_log_dt, A_Dskip)
    x = x + _B_ref(_layernorm(x, axis=-1), B_wqkv, B_wo)
    x = x + _A_ref(_layernorm(x, axis=-1), A_A_re, A_A_im, A_B_re, A_B_im, A_C_re, A_C_im, A_log_dt, A_Dskip)
    x = x + _B_ref(_layernorm(x, axis=-1), B_wqkv, B_wo)
    return x
```

```asm
; @launch kernel=prep_kernel grid=(664,1,1) block=(256,1,1) lds=34816
; @launch kernel=conv1_kernel grid=(256,1,1) block=(256,1,1) lds=100352
; @launch kernel=qkv1_kernel grid=(256,1,1) block=(256,1,1) lds=82432
; @launch kernel=attn1_kernel grid=(512,1,1) block=(256,1,1) lds=0
; @launch kernel=oproj1_kernel grid=(256,1,1) block=(256,1,1) lds=32768
; @launch kernel=conv2_kernel grid=(256,1,1) block=(256,1,1) lds=100352
; @launch kernel=qkv2_kernel grid=(256,1,1) block=(256,1,1) lds=82432
; @launch kernel=attn1_kernel grid=(512,1,1) block=(256,1,1) lds=0
; @launch kernel=oproj2_kernel grid=(256,1,1) block=(256,1,1) lds=32768
.amdgcn_target "amdgcn-amd-amdhsa--gfx950"
.text
.globl prep_kernel
.p2align 8
.type prep_kernel,@function
prep_kernel:
    s_cmp_ge_u32 s2, 664
    s_cbranch_scc1 prep_kernel_end
    s_add_u32 s3, s2, 64
    s_sub_u32 s4, s2, 512
    s_cmp_lt_u32 s2, 576
    s_cselect_b32 s3, s3, s4
    s_cmp_lt_u32 s2, 64
    s_cselect_b32 s3, s2, s3
    s_cmp_lt_u32 s2, 640
    s_cselect_b32 s2, s3, s2
    s_cmp_ge_u32 s2, 128
    s_cbranch_scc1 prep_kgen
    s_load_dwordx2 s[4:5], s[0:1], 0
    s_load_dwordx2 s[6:7], s[0:1], 80
    s_load_dwordx2 s[8:9], s[0:1], 88
    s_load_dwordx2 s[10:11], s[0:1], 112
    s_waitcnt lgkmcnt(0)
    s_mov_b32 s16, s10
    s_and_b32 s17, s11, 0xffff
    s_mov_b32 s18, 0x10000000
    s_mov_b32 s19, 0x00020000
    s_cmp_ge_u32 s2, 64
    s_cbranch_scc1 prep_m1
    s_mov_b32 s12, s4
    s_and_b32 s13, s5, 0xffff
    s_mov_b32 s14, 0x200000
    s_mov_b32 s15, 0x00020000
    s_lshl_b32 s20, s2, 15
    s_mov_b32 s21, 1024
    s_lshl_b32 s22, s2, 6
    s_add_u32 s22, s22, 0
    s_mov_b32 s23, 0x100000
    s_mov_b32 s24, 0
    v_lshlrev_b32 v50, 12, v0
    s_branch prep_go
prep_m1:
    s_cmp_ge_u32 s2, 112
    s_cbranch_scc1 prep_m2
    s_mov_b32 s12, s6
    s_and_b32 s13, s7, 0xffff
    s_mov_b32 s14, 0x180000
    s_mov_b32 s15, 0x00020000
    s_sub_u32 s3, s2, 64
    s_lshr_b32 s25, s3, 4
    s_and_b32 s26, s3, 15
    s_mul_i32 s20, s26, 98304
    s_lshl_b32 s27, s25, 10
    s_add_u32 s20, s20, s27
    s_mov_b32 s21, 3072
    s_lshl_b32 s22, s25, 14
    s_lshl_b32 s27, s26, 10
    s_add_u32 s22, s22, s27
    s_add_u32 s22, s22, 13631488
    s_mov_b32 s23, 786432
    s_mov_b32 s24, 1
    v_lshrrev_b32 v6, 4, v0
    v_mul_u32_u24 v6, 49152, v6
    v_and_b32 v7, 15, v0
    v_lshl_add_u32 v50, v7, 4, v6
    s_branch prep_go
prep_m2:
    s_mov_b32 s12, s8
    s_and_b32 s13, s9, 0xffff
    s_mov_b32 s14, 0x80000
    s_mov_b32 s15, 0x00020000
    s_sub_u32 s3, s2, 112
    s_lshl_b32 s20, s3, 15
    s_mov_b32 s21, 1024
    s_lshl_b32 s22, s3, 11
    s_add_u32 s22, s22, 15728640
    s_mov_b32 s23, 262144
    s_mov_b32 s24, 2
    v_lshrrev_b32 v6, 5, v0
    v_lshlrev_b32 v6, 15, v6
    v_and_b32 v7, 31, v0
    v_lshl_add_u32 v50, v7, 4, v6
prep_go:
    v_lshrrev_b32 v1, 3, v0
    v_and_b32 v2, 7, v0
    v_mul_lo_u32 v3, v1, s21
    v_lshl_add_u32 v3, v2, 4, v3
    v_mul_u32_u24 v4, 1088, v1
    v_lshl_add_u32 v4, v2, 4, v4
    buffer_load_dwordx4 v[8:11], v3, s[12:15], s20 offen offset:0
    buffer_load_dwordx4 v[12:15], v3, s[12:15], s20 offen offset:128
    buffer_load_dwordx4 v[16:19], v3, s[12:15], s20 offen offset:256
    buffer_load_dwordx4 v[20:23], v3, s[12:15], s20 offen offset:384
    buffer_load_dwordx4 v[24:27], v3, s[12:15], s20 offen offset:512
    buffer_load_dwordx4 v[28:31], v3, s[12:15], s20 offen offset:640
    buffer_load_dwordx4 v[32:35], v3, s[12:15], s20 offen offset:768
    buffer_load_dwordx4 v[36:39], v3, s[12:15], s20 offen offset:896
    v_and_b32 v5, 15, v0
    v_lshrrev_b32 v5, 2, v5
    v_mul_u32_u24 v5, 1088, v5
    v_and_b32 v6, 0xf0, v0
    v_and_b32 v7, 3, v0
    v_lshl_add_u32 v6, v7, 2, v6
    v_lshl_add_u32 v5, v6, 1, v5
    s_waitcnt vmcnt(7)
    ds_write_b128 v4, v[8:11] offset:0
    s_waitcnt vmcnt(6)
    ds_write_b128 v4, v[12:15] offset:128
    s_waitcnt vmcnt(5)
    ds_write_b128 v4, v[16:19] offset:256
    s_waitcnt vmcnt(4)
    ds_write_b128 v4, v[20:23] offset:384
    s_waitcnt vmcnt(3)
    ds_write_b128 v4, v[24:27] offset:512
    s_waitcnt vmcnt(2)
    ds_write_b128 v4, v[28:31] offset:640
    s_waitcnt vmcnt(1)
    ds_write_b128 v4, v[32:35] offset:768
    s_waitcnt vmcnt(0)
    ds_write_b128 v4, v[36:39] offset:896
    s_cmp_lg_u32 s24, 0
    s_cbranch_scc1 prep_nostats
    v_mov_b32 v60, 0
    v_mov_b32 v61, 0
    v_lshlrev_b32 v62, 16, v8
    v_and_b32 v63, 0xffff0000, v8
    v_add_f32 v60, v60, v62
    v_fmac_f32 v61, v62, v62
    v_add_f32 v60, v60, v63
    v_fmac_f32 v61, v63, v63
    v_lshlrev_b32 v62, 16, v9
    v_and_b32 v63, 0xffff0000, v9
    v_add_f32 v60, v60, v62
    v_fmac_f32 v61, v62, v62
    v_add_f32 v60, v60, v63
    v_fmac_f32 v61, v63, v63
    v_lshlrev_b32 v62, 16, v10
    v_and_b32 v63, 0xffff0000, v10
    v_add_f32 v60, v60, v62
    v_fmac_f32 v61, v62, v62
    v_add_f32 v60, v60, v63
    v_fmac_f32 v61, v63, v63
    v_lshlrev_b32 v62, 16, v11
    v_and_b32 v63, 0xffff0000, v11
    v_add_f32 v60, v60, v62
    v_fmac_f32 v61, v62, v62
    v_add_f32 v60, v60, v63
    v_fmac_f32 v61, v63, v63
    v_lshlrev_b32 v62, 16, v12
    v_and_b32 v63, 0xffff0000, v12
    v_add_f32 v60, v60, v62
    v_fmac_f32 v61, v62, v62
    v_add_f32 v60, v60, v63
    v_fmac_f32 v61, v63, v63
    v_lshlrev_b32 v62, 16, v13
    v_and_b32 v63, 0xffff0000, v13
    v_add_f32 v60, v60, v62
    v_fmac_f32 v61, v62, v62
    v_add_f32 v60, v60, v63
    v_fmac_f32 v61, v63, v63
    v_lshlrev_b32 v62, 16, v14
    v_and_b32 v63, 0xffff0000, v14
    v_add_f32 v60, v60, v62
    v_fmac_f32 v61, v62, v62
    v_add_f32 v60, v60, v63
    v_fmac_f32 v61, v63, v63
    v_lshlrev_b32 v62, 16, v15
    v_and_b32 v63, 0xffff0000, v15
    v_add_f32 v60, v60, v62
    v_fmac_f32 v61, v62, v62
    v_add_f32 v60, v60, v63
    v_fmac_f32 v61, v63, v63
    v_lshlrev_b32 v62, 16, v16
    v_and_b32 v63, 0xffff0000, v16
    v_add_f32 v60, v60, v62
    v_fmac_f32 v61, v62, v62
    v_add_f32 v60, v60, v63
    v_fmac_f32 v61, v63, v63
    v_lshlrev_b32 v62, 16, v17
    v_and_b32 v63, 0xffff0000, v17
    v_add_f32 v60, v60, v62
    v_fmac_f32 v61, v62, v62
    v_add_f32 v60, v60, v63
    v_fmac_f32 v61, v63, v63
    v_lshlrev_b32 v62, 16, v18
    v_and_b32 v63, 0xffff0000, v18
    v_add_f32 v60, v60, v62
    v_fmac_f32 v61, v62, v62
    v_add_f32 v60, v60, v63
    v_fmac_f32 v61, v63, v63
    v_lshlrev_b32 v62, 16, v19
    v_and_b32 v63, 0xffff0000, v19
    v_add_f32 v60, v60, v62
    v_fmac_f32 v61, v62, v62
    v_add_f32 v60, v60, v63
    v_fmac_f32 v61, v63, v63
    v_lshlrev_b32 v62, 16, v20
    v_and_b32 v63, 0xffff0000, v20
    v_add_f32 v60, v60, v62
    v_fmac_f32 v61, v62, v62
    v_add_f32 v60, v60, v63
    v_fmac_f32 v61, v63, v63
    v_lshlrev_b32 v62, 16, v21
    v_and_b32 v63, 0xffff0000, v21
    v_add_f32 v60, v60, v62
    v_fmac_f32 v61, v62, v62
    v_add_f32 v60, v60, v63
    v_fmac_f32 v61, v63, v63
    v_lshlrev_b32 v62, 16, v22
    v_and_b32 v63, 0xffff0000, v22
    v_add_f32 v60, v60, v62
    v_fmac_f32 v61, v62, v62
    v_add_f32 v60, v60, v63
    v_fmac_f32 v61, v63, v63
    v_lshlrev_b32 v62, 16, v23
    v_and_b32 v63, 0xffff0000, v23
    v_add_f32 v60, v60, v62
    v_fmac_f32 v61, v62, v62
    v_add_f32 v60, v60, v63
    v_fmac_f32 v61, v63, v63
    v_lshlrev_b32 v62, 16, v24
    v_and_b32 v63, 0xffff0000, v24
    v_add_f32 v60, v60, v62
    v_fmac_f32 v61, v62, v62
    v_add_f32 v60, v60, v63
    v_fmac_f32 v61, v63, v63
    v_lshlrev_b32 v62, 16, v25
    v_and_b32 v63, 0xffff0000, v25
    v_add_f32 v60, v60, v62
    v_fmac_f32 v61, v62, v62
    v_add_f32 v60, v60, v63
    v_fmac_f32 v61, v63, v63
    v_lshlrev_b32 v62, 16, v26
    v_and_b32 v63, 0xffff0000, v26
    v_add_f32 v60, v60, v62
    v_fmac_f32 v61, v62, v62
    v_add_f32 v60, v60, v63
    v_fmac_f32 v61, v63, v63
    v_lshlrev_b32 v62, 16, v27
    v_and_b32 v63, 0xffff0000, v27
    v_add_f32 v60, v60, v62
    v_fmac_f32 v61, v62, v62
    v_add_f32 v60, v60, v63
    v_fmac_f32 v61, v63, v63
    v_lshlrev_b32 v62, 16, v28
    v_and_b32 v63, 0xffff0000, v28
    v_add_f32 v60, v60, v62
    v_fmac_f32 v61, v62, v62
    v_add_f32 v60, v60, v63
    v_fmac_f32 v61, v63, v63
    v_lshlrev_b32 v62, 16, v29
    v_and_b32 v63, 0xffff0000, v29
    v_add_f32 v60, v60, v62
    v_fmac_f32 v61, v62, v62
    v_add_f32 v60, v60, v63
    v_fmac_f32 v61, v63, v63
    v_lshlrev_b32 v62, 16, v30
    v_and_b32 v63, 0xffff0000, v30
    v_add_f32 v60, v60, v62
    v_fmac_f32 v61, v62, v62
    v_add_f32 v60, v60, v63
    v_fmac_f32 v61, v63, v63
    v_lshlrev_b32 v62, 16, v31
    v_and_b32 v63, 0xffff0000, v31
    v_add_f32 v60, v60, v62
    v_fmac_f32 v61, v62, v62
    v_add_f32 v60, v60, v63
    v_fmac_f32 v61, v63, v63
    v_lshlrev_b32 v62, 16, v32
    v_and_b32 v63, 0xffff0000, v32
    v_add_f32 v60, v60, v62
    v_fmac_f32 v61, v62, v62
    v_add_f32 v60, v60, v63
    v_fmac_f32 v61, v63, v63
    v_lshlrev_b32 v62, 16, v33
    v_and_b32 v63, 0xffff0000, v33
    v_add_f32 v60, v60, v62
    v_fmac_f32 v61, v62, v62
    v_add_f32 v60, v60, v63
    v_fmac_f32 v61, v63, v63
    v_lshlrev_b32 v62, 16, v34
    v_and_b32 v63, 0xffff0000, v34
    v_add_f32 v60, v60, v62
    v_fmac_f32 v61, v62, v62
    v_add_f32 v60, v60, v63
    v_fmac_f32 v61, v63, v63
    v_lshlrev_b32 v62, 16, v35
    v_and_b32 v63, 0xffff0000, v35
    v_add_f32 v60, v60, v62
    v_fmac_f32 v61, v62, v62
    v_add_f32 v60, v60, v63
    v_fmac_f32 v61, v63, v63
    v_lshlrev_b32 v62, 16, v36
    v_and_b32 v63, 0xffff0000, v36
    v_add_f32 v60, v60, v62
    v_fmac_f32 v61, v62, v62
    v_add_f32 v60, v60, v63
    v_fmac_f32 v61, v63, v63
    v_lshlrev_b32 v62, 16, v37
    v_and_b32 v63, 0xffff0000, v37
    v_add_f32 v60, v60, v62
    v_fmac_f32 v61, v62, v62
    v_add_f32 v60, v60, v63
    v_fmac_f32 v61, v63, v63
    v_lshlrev_b32 v62, 16, v38
    v_and_b32 v63, 0xffff0000, v38
    v_add_f32 v60, v60, v62
    v_fmac_f32 v61, v62, v62
    v_add_f32 v60, v60, v63
    v_fmac_f32 v61, v63, v63
    v_lshlrev_b32 v62, 16, v39
    v_and_b32 v63, 0xffff0000, v39
    v_add_f32 v60, v60, v62
    v_fmac_f32 v61, v62, v62
    v_add_f32 v60, v60, v63
    v_fmac_f32 v61, v63, v63
    s_nop 1
    v_add_f32_dpp v60, v60, v60 quad_perm:[1,0,3,2] row_mask:0xf bank_mask:0xf
    v_add_f32_dpp v61, v61, v61 quad_perm:[1,0,3,2] row_mask:0xf bank_mask:0xf
    s_nop 1
    v_add_f32_dpp v60, v60, v60 quad_perm:[2,3,0,1] row_mask:0xf bank_mask:0xf
    v_add_f32_dpp v61, v61, v61 quad_perm:[2,3,0,1] row_mask:0xf bank_mask:0xf
    s_nop 1
    v_add_f32_dpp v60, v60, v60 row_half_mirror row_mask:0xf bank_mask:0xf
    v_add_f32_dpp v61, v61, v61 row_half_mirror row_mask:0xf bank_mask:0xf
    s_lshl_b32 s3, s2, 8
    s_add_u32 s3, s3, 25165824
    v_lshlrev_b32 v62, 3, v1
    v_cmp_eq_u32 vcc, 0, v2
    s_and_saveexec_b64 s[28:29], vcc
    buffer_store_dwordx2 v[60:61], v62, s[16:19], s3 offen
    s_mov_b64 exec, s[28:29]
prep_nostats:
    s_waitcnt lgkmcnt(0)
    s_barrier
    s_add_u32 s25, s23, s22
    s_cmp_eq_u32 s24, 1
    s_cbranch_scc1 prep_perm
    s_cmp_eq_u32 s24, 2
    s_cbranch_scc1 prep_wo
    ds_read_b64_tr_b16 v[8:9], v5 offset:0
    ds_read_b64_tr_b16 v[10:11], v5 offset:4352
    ds_read_b64_tr_b16 v[12:13], v5 offset:8704
    ds_read_b64_tr_b16 v[14:15], v5 offset:13056
    ds_read_b64_tr_b16 v[16:17], v5 offset:17408
    ds_read_b64_tr_b16 v[18:19], v5 offset:21760
    ds_read_b64_tr_b16 v[20:21], v5 offset:26112
    ds_read_b64_tr_b16 v[22:23], v5 offset:30464
    ds_read_b64_tr_b16 v[24:25], v5 offset:512
    ds_read_b64_tr_b16 v[26:27], v5 offset:4864
    ds_read_b64_tr_b16 v[28:29], v5 offset:9216
    ds_read_b64_tr_b16 v[30:31], v5 offset:13568
    ds_read_b64_tr_b16 v[32:33], v5 offset:17920
    ds_read_b64_tr_b16 v[34:35], v5 offset:22272
    ds_read_b64_tr_b16 v[36:37], v5 offset:26624
    ds_read_b64_tr_b16 v[38:39], v5 offset:30976
    s_waitcnt lgkmcnt(8)
    buffer_store_dwordx4 v[8:11], v50, s[16:19], s22 offen offset:0
    buffer_store_dwordx4 v[12:15], v50, s[16:19], s22 offen offset:16
    buffer_store_dwordx4 v[16:19], v50, s[16:19], s22 offen offset:32
    buffer_store_dwordx4 v[20:23], v50, s[16:19], s22 offen offset:48
    s_waitcnt lgkmcnt(0)
    buffer_store_dwordx4 v[24:27], v50, s[16:19], s25 offen offset:0
    buffer_store_dwordx4 v[28:31], v50, s[16:19], s25 offen offset:16
    buffer_store_dwordx4 v[32:35], v50, s[16:19], s25 offen offset:32
    buffer_store_dwordx4 v[36:39], v50, s[16:19], s25 offen offset:48
    s_endpgm
prep_perm:
    ds_read_b64_tr_b16 v[8:9], v5 offset:0
    ds_read_b64_tr_b16 v[12:13], v5 offset:4352
    ds_read_b64_tr_b16 v[16:17], v5 offset:8704
    ds_read_b64_tr_b16 v[20:21], v5 offset:13056
    ds_read_b64_tr_b16 v[10:11], v5 offset:17408
    ds_read_b64_tr_b16 v[14:15], v5 offset:21760
    ds_read_b64_tr_b16 v[18:19], v5 offset:26112
    ds_read_b64_tr_b16 v[22:23], v5 offset:30464
    ds_read_b64_tr_b16 v[24:25], v5 offset:512
    ds_read_b64_tr_b16 v[28:29], v5 offset:4864
    ds_read_b64_tr_b16 v[32:33], v5 offset:9216
    ds_read_b64_tr_b16 v[36:37], v5 offset:13568
    ds_read_b64_tr_b16 v[26:27], v5 offset:17920
    ds_read_b64_tr_b16 v[30:31], v5 offset:22272
    ds_read_b64_tr_b16 v[34:35], v5 offset:26624
    ds_read_b64_tr_b16 v[38:39], v5 offset:30976
    s_waitcnt lgkmcnt(8)
    buffer_store_dwordx4 v[8:11], v50, s[16:19], s22 offen offset:0
    buffer_store_dwordx4 v[12:15], v50, s[16:19], s22 offen offset:256
    buffer_store_dwordx4 v[16:19], v50, s[16:19], s22 offen offset:512
    buffer_store_dwordx4 v[20:23], v50, s[16:19], s22 offen offset:768
    s_waitcnt lgkmcnt(0)
    buffer_store_dwordx4 v[24:27], v50, s[16:19], s25 offen offset:0
    buffer_store_dwordx4 v[28:31], v50, s[16:19], s25 offen offset:256
    buffer_store_dwordx4 v[32:35], v50, s[16:19], s25 offen offset:512
    buffer_store_dwordx4 v[36:39], v50, s[16:19], s25 offen offset:768
    s_endpgm
prep_wo:
    ds_read_b64_tr_b16 v[8:9], v5 offset:0
    ds_read_b64_tr_b16 v[10:11], v5 offset:4352
    ds_read_b64_tr_b16 v[12:13], v5 offset:8704
    ds_read_b64_tr_b16 v[14:15], v5 offset:13056
    ds_read_b64_tr_b16 v[16:17], v5 offset:17408
    ds_read_b64_tr_b16 v[18:19], v5 offset:21760
    ds_read_b64_tr_b16 v[20:21], v5 offset:26112
    ds_read_b64_tr_b16 v[22:23], v5 offset:30464
    ds_read_b64_tr_b16 v[24:25], v5 offset:512
    ds_read_b64_tr_b16 v[26:27], v5 offset:4864
    ds_read_b64_tr_b16 v[28:29], v5 offset:9216
    ds_read_b64_tr_b16 v[30:31], v5 offset:13568
    ds_read_b64_tr_b16 v[32:33], v5 offset:17920
    ds_read_b64_tr_b16 v[34:35], v5 offset:22272
    ds_read_b64_tr_b16 v[36:37], v5 offset:26624
    ds_read_b64_tr_b16 v[38:39], v5 offset:30976
    s_waitcnt lgkmcnt(8)
    buffer_store_dwordx4 v[8:11], v50, s[16:19], s22 offen offset:0
    buffer_store_dwordx4 v[12:15], v50, s[16:19], s22 offen offset:512
    buffer_store_dwordx4 v[16:19], v50, s[16:19], s22 offen offset:1024
    buffer_store_dwordx4 v[20:23], v50, s[16:19], s22 offen offset:1536
    s_waitcnt lgkmcnt(0)
    buffer_store_dwordx4 v[24:27], v50, s[16:19], s25 offen offset:0
    buffer_store_dwordx4 v[28:31], v50, s[16:19], s25 offen offset:512
    buffer_store_dwordx4 v[32:35], v50, s[16:19], s25 offen offset:1024
    buffer_store_dwordx4 v[36:39], v50, s[16:19], s25 offen offset:1536
    s_endpgm
prep_cs:
    s_load_dwordx2 s[6:7], s[0:1], 80
    s_load_dwordx2 s[10:11], s[0:1], 112
    s_sub_u32 s3, s2, 640
    s_lshl_b32 s20, s3, 7
    v_lshrrev_b32 v1, 3, v0
    v_and_b32 v2, 7, v0
    v_mul_u32_u24 v3, 3072, v1
    v_lshl_add_u32 v3, v2, 4, v3
    v_lshlrev_b32 v4, 5, v0
    v_lshlrev_b32 v5, 2, v0
    s_waitcnt lgkmcnt(0)
    s_mov_b32 s12, s6
    s_and_b32 s13, s7, 0xffff
    s_mov_b32 s14, 0x180000
    s_mov_b32 s15, 0x00020000
    s_mov_b32 s16, s10
    s_and_b32 s17, s11, 0xffff
    s_mov_b32 s18, 0x10000000
    s_mov_b32 s19, 0x00020000
    buffer_load_dwordx4 v[16:19], v3, s[12:15], s20 offen
    s_add_u32 s20, s20, 98304
    buffer_load_dwordx4 v[20:23], v3, s[12:15], s20 offen
    s_add_u32 s20, s20, 98304
    buffer_load_dwordx4 v[24:27], v3, s[12:15], s20 offen
    s_add_u32 s20, s20, 98304
    buffer_load_dwordx4 v[28:31], v3, s[12:15], s20 offen
    s_add_u32 s20, s20, 98304
    buffer_load_dwordx4 v[32:35], v3, s[12:15], s20 offen
    s_add_u32 s20, s20, 98304
    buffer_load_dwordx4 v[36:39], v3, s[12:15], s20 offen
    s_add_u32 s20, s20, 98304
    buffer_load_dwordx4 v[40:43], v3, s[12:15], s20 offen
    s_add_u32 s20, s20, 98304
    buffer_load_dwordx4 v[44:47], v3, s[12:15], s20 offen
    s_add_u32 s20, s20, 98304
    buffer_load_dwordx4 v[48:51], v3, s[12:15], s20 offen
    s_add_u32 s20, s20, 98304
    buffer_load_dwordx4 v[52:55], v3, s[12:15], s20 offen
    s_add_u32 s20, s20, 98304
    buffer_load_dwordx4 v[56:59], v3, s[12:15], s20 offen
    s_add_u32 s20, s20, 98304
    buffer_load_dwordx4 v[60:63], v3, s[12:15], s20 offen
    s_add_u32 s20, s20, 98304
    buffer_load_dwordx4 v[64:67], v3, s[12:15], s20 offen
    s_add_u32 s20, s20, 98304
    buffer_load_dwordx4 v[68:71], v3, s[12:15], s20 offen
    s_add_u32 s20, s20, 98304
    buffer_load_dwordx4 v[72:75], v3, s[12:15], s20 offen
    s_add_u32 s20, s20, 98304
    buffer_load_dwordx4 v[76:79], v3, s[12:15], s20 offen
    s_waitcnt vmcnt(15)
    v_lshlrev_b32 v80, 16, v16
    v_and_b32 v81, 0xffff0000, v16
    v_lshlrev_b32 v82, 16, v17
    v_and_b32 v83, 0xffff0000, v17
    v_lshlrev_b32 v84, 16, v18
    v_and_b32 v85, 0xffff0000, v18
    v_lshlrev_b32 v86, 16, v19
    v_and_b32 v87, 0xffff0000, v19
    s_waitcnt vmcnt(14)
    v_lshlrev_b32 v8, 16, v20
    v_and_b32 v9, 0xffff0000, v20
    v_pk_add_f32 v[80:81], v[80:81], v[8:9]
    v_lshlrev_b32 v10, 16, v21
    v_and_b32 v11, 0xffff0000, v21
    v_pk_add_f32 v[82:83], v[82:83], v[10:11]
    v_lshlrev_b32 v12, 16, v22
    v_and_b32 v13, 0xffff0000, v22
    v_pk_add_f32 v[84:85], v[84:85], v[12:13]
    v_lshlrev_b32 v14, 16, v23
    v_and_b32 v15, 0xffff0000, v23
    v_pk_add_f32 v[86:87], v[86:87], v[14:15]
    s_waitcnt vmcnt(13)
    v_lshlrev_b32 v8, 16, v24
    v_and_b32 v9, 0xffff0000, v24
    v_pk_add_f32 v[80:81], v[80:81], v[8:9]
    v_lshlrev_b32 v10, 16, v25
    v_and_b32 v11, 0xffff0000, v25
    v_pk_add_f32 v[82:83], v[82:83], v[10:11]
    v_lshlrev_b32 v12, 16, v26
    v_and_b32 v13, 0xffff0000, v26
    v_pk_add_f32 v[84:85], v[84:85], v[12:13]
    v_lshlrev_b32 v14, 16, v27
    v_and_b32 v15, 0xffff0000, v27
    v_pk_add_f32 v[86:87], v[86:87], v[14:15]
    s_waitcnt vmcnt(12)
    v_lshlrev_b32 v8, 16, v28
    v_and_b32 v9, 0xffff0000, v28
    v_pk_add_f32 v[80:81], v[80:81], v[8:9]
    v_lshlrev_b32 v10, 16, v29
    v_and_b32 v11, 0xffff0000, v29
    v_pk_add_f32 v[82:83], v[82:83], v[10:11]
    v_lshlrev_b32 v12, 16, v30
    v_and_b32 v13, 0xffff0000, v30
    v_pk_add_f32 v[84:85], v[84:85], v[12:13]
    v_lshlrev_b32 v14, 16, v31
    v_and_b32 v15, 0xffff0000, v31
    v_pk_add_f32 v[86:87], v[86:87], v[14:15]
    s_waitcnt vmcnt(11)
    v_lshlrev_b32 v8, 16, v32
    v_and_b32 v9, 0xffff0000, v32
    v_pk_add_f32 v[80:81], v[80:81], v[8:9]
    v_lshlrev_b32 v10, 16, v33
    v_and_b32 v11, 0xffff0000, v33
    v_pk_add_f32 v[82:83], v[82:83], v[10:11]
    v_lshlrev_b32 v12, 16, v34
    v_and_b32 v13, 0xffff0000, v34
    v_pk_add_f32 v[84:85], v[84:85], v[12:13]
    v_lshlrev_b32 v14, 16, v35
    v_and_b32 v15, 0xffff0000, v35
    v_pk_add_f32 v[86:87], v[86:87], v[14:15]
    s_waitcnt vmcnt(10)
    v_lshlrev_b32 v8, 16, v36
    v_and_b32 v9, 0xffff0000, v36
    v_pk_add_f32 v[80:81], v[80:81], v[8:9]
    v_lshlrev_b32 v10, 16, v37
    v_and_b32 v11, 0xffff0000, v37
    v_pk_add_f32 v[82:83], v[82:83], v[10:11]
    v_lshlrev_b32 v12, 16, v38
    v_and_b32 v13, 0xffff0000, v38
    v_pk_add_f32 v[84:85], v[84:85], v[12:13]
    v_lshlrev_b32 v14, 16, v39
    v_and_b32 v15, 0xffff0000, v39
    v_pk_add_f32 v[86:87], v[86:87], v[14:15]
    s_waitcnt vmcnt(9)
    v_lshlrev_b32 v8, 16, v40
    v_and_b32 v9, 0xffff0000, v40
    v_pk_add_f32 v[80:81], v[80:81], v[8:9]
    v_lshlrev_b32 v10, 16, v41
    v_and_b32 v11, 0xffff0000, v41
    v_pk_add_f32 v[82:83], v[82:83], v[10:11]
    v_lshlrev_b32 v12, 16, v42
    v_and_b32 v13, 0xffff0000, v42
    v_pk_add_f32 v[84:85], v[84:85], v[12:13]
    v_lshlrev_b32 v14, 16, v43
    v_and_b32 v15, 0xffff0000, v43
    v_pk_add_f32 v[86:87], v[86:87], v[14:15]
    s_waitcnt vmcnt(8)
    v_lshlrev_b32 v8, 16, v44
    v_and_b32 v9, 0xffff0000, v44
    v_pk_add_f32 v[80:81], v[80:81], v[8:9]
    v_lshlrev_b32 v10, 16, v45
    v_and_b32 v11, 0xffff0000, v45
    v_pk_add_f32 v[82:83], v[82:83], v[10:11]
    v_lshlrev_b32 v12, 16, v46
    v_and_b32 v13, 0xffff0000, v46
    v_pk_add_f32 v[84:85], v[84:85], v[12:13]
    v_lshlrev_b32 v14, 16, v47
    v_and_b32 v15, 0xffff0000, v47
    v_pk_add_f32 v[86:87], v[86:87], v[14:15]
    s_waitcnt vmcnt(7)
    v_lshlrev_b32 v8, 16, v48
    v_and_b32 v9, 0xffff0000, v48
    v_pk_add_f32 v[80:81], v[80:81], v[8:9]
    v_lshlrev_b32 v10, 16, v49
    v_and_b32 v11, 0xffff0000, v49
    v_pk_add_f32 v[82:83], v[82:83], v[10:11]
    v_lshlrev_b32 v12, 16, v50
    v_and_b32 v13, 0xffff0000, v50
    v_pk_add_f32 v[84:85], v[84:85], v[12:13]
    v_lshlrev_b32 v14, 16, v51
    v_and_b32 v15, 0xffff0000, v51
    v_pk_add_f32 v[86:87], v[86:87], v[14:15]
    s_waitcnt vmcnt(6)
    v_lshlrev_b32 v8, 16, v52
    v_and_b32 v9, 0xffff0000, v52
    v_pk_add_f32 v[80:81], v[80:81], v[8:9]
    v_lshlrev_b32 v10, 16, v53
    v_and_b32 v11, 0xffff0000, v53
    v_pk_add_f32 v[82:83], v[82:83], v[10:11]
    v_lshlrev_b32 v12, 16, v54
    v_and_b32 v13, 0xffff0000, v54
    v_pk_add_f32 v[84:85], v[84:85], v[12:13]
    v_lshlrev_b32 v14, 16, v55
    v_and_b32 v15, 0xffff0000, v55
    v_pk_add_f32 v[86:87], v[86:87], v[14:15]
    s_waitcnt vmcnt(5)
    v_lshlrev_b32 v8, 16, v56
    v_and_b32 v9, 0xffff0000, v56
    v_pk_add_f32 v[80:81], v[80:81], v[8:9]
    v_lshlrev_b32 v10, 16, v57
    v_and_b32 v11, 0xffff0000, v57
    v_pk_add_f32 v[82:83], v[82:83], v[10:11]
    v_lshlrev_b32 v12, 16, v58
    v_and_b32 v13, 0xffff0000, v58
    v_pk_add_f32 v[84:85], v[84:85], v[12:13]
    v_lshlrev_b32 v14, 16, v59
    v_and_b32 v15, 0xffff0000, v59
    v_pk_add_f32 v[86:87], v[86:87], v[14:15]
    s_waitcnt vmcnt(4)
    v_lshlrev_b32 v8, 16, v60
    v_and_b32 v9, 0xffff0000, v60
    v_pk_add_f32 v[80:81], v[80:81], v[8:9]
    v_lshlrev_b32 v10, 16, v61
    v_and_b32 v11, 0xffff0000, v61
    v_pk_add_f32 v[82:83], v[82:83], v[10:11]
    v_lshlrev_b32 v12, 16, v62
    v_and_b32 v13, 0xffff0000, v62
    v_pk_add_f32 v[84:85], v[84:85], v[12:13]
    v_lshlrev_b32 v14, 16, v63
    v_and_b32 v15, 0xffff0000, v63
    v_pk_add_f32 v[86:87], v[86:87], v[14:15]
    s_waitcnt vmcnt(3)
    v_lshlrev_b32 v8, 16, v64
    v_and_b32 v9, 0xffff0000, v64
    v_pk_add_f32 v[80:81], v[80:81], v[8:9]
    v_lshlrev_b32 v10, 16, v65
    v_and_b32 v11, 0xffff0000, v65
    v_pk_add_f32 v[82:83], v[82:83], v[10:11]
    v_lshlrev_b32 v12, 16, v66
    v_and_b32 v13, 0xffff0000, v66
    v_pk_add_f32 v[84:85], v[84:85], v[12:13]
    v_lshlrev_b32 v14, 16, v67
    v_and_b32 v15, 0xffff0000, v67
    v_pk_add_f32 v[86:87], v[86:87], v[14:15]
    s_waitcnt vmcnt(2)
    v_lshlrev_b32 v8, 16, v68
    v_and_b32 v9, 0xffff0000, v68
    v_pk_add_f32 v[80:81], v[80:81], v[8:9]
    v_lshlrev_b32 v10, 16, v69
    v_and_b32 v11, 0xffff0000, v69
    v_pk_add_f32 v[82:83], v[82:83], v[10:11]
    v_lshlrev_b32 v12, 16, v70
    v_and_b32 v13, 0xffff0000, v70
    v_pk_add_f32 v[84:85], v[84:85], v[12:13]
    v_lshlrev_b32 v14, 16, v71
    v_and_b32 v15, 0xffff0000, v71
    v_pk_add_f32 v[86:87], v[86:87], v[14:15]
    s_waitcnt vmcnt(1)
    v_lshlrev_b32 v8, 16, v72
    v_and_b32 v9, 0xffff0000, v72
    v_pk_add_f32 v[80:81], v[80:81], v[8:9]
    v_lshlrev_b32 v10, 16, v73
    v_and_b32 v11, 0xffff0000, v73
    v_pk_add_f32 v[82:83], v[82:83], v[10:11]
    v_lshlrev_b32 v12, 16, v74
    v_and_b32 v13, 0xffff0000, v74
    v_pk_add_f32 v[84:85], v[84:85], v[12:13]
    v_lshlrev_b32 v14, 16, v75
    v_and_b32 v15, 0xffff0000, v75
    v_pk_add_f32 v[86:87], v[86:87], v[14:15]
    s_waitcnt vmcnt(0)
    v_lshlrev_b32 v8, 16, v76
    v_and_b32 v9, 0xffff0000, v76
    v_pk_add_f32 v[80:81], v[80:81], v[8:9]
    v_lshlrev_b32 v10, 16, v77
    v_and_b32 v11, 0xffff0000, v77
    v_pk_add_f32 v[82:83], v[82:83], v[10:11]
    v_lshlrev_b32 v12, 16, v78
    v_and_b32 v13, 0xffff0000, v78
    v_pk_add_f32 v[84:85], v[84:85], v[12:13]
    v_lshlrev_b32 v14, 16, v79
    v_and_b32 v15, 0xffff0000, v79
    v_pk_add_f32 v[86:87], v[86:87], v[14:15]
    ds_write_b128 v4, v[80:83]
    ds_write_b128 v4, v[84:87] offset:16
    s_waitcnt lgkmcnt(0)
    s_barrier
    v_cmp_gt_u32 vcc, 64, v0
    s_and_saveexec_b64 s[28:29], vcc
    s_cbranch_execz prep_kernel_end
    ds_read_b32 v16, v5 offset:0
    ds_read_b32 v17, v5 offset:256
    ds_read_b32 v18, v5 offset:512
    ds_read_b32 v19, v5 offset:768
    ds_read_b32 v20, v5 offset:1024
    ds_read_b32 v21, v5 offset:1280
    ds_read_b32 v22, v5 offset:1536
    ds_read_b32 v23, v5 offset:1792
    ds_read_b32 v24, v5 offset:2048
    ds_read_b32 v25, v5 offset:2304
    ds_read_b32 v26, v5 offset:2560
    ds_read_b32 v27, v5 offset:2816
    ds_read_b32 v28, v5 offset:3072
    ds_read_b32 v29, v5 offset:3328
    ds_read_b32 v30, v5 offset:3584
    ds_read_b32 v31, v5 offset:3840
    ds_read_b32 v32, v5 offset:4096
    ds_read_b32 v33, v5 offset:4352
    ds_read_b32 v34, v5 offset:4608
    ds_read_b32 v35, v5 offset:4864
    ds_read_b32 v36, v5 offset:5120
    ds_read_b32 v37, v5 offset:5376
    ds_read_b32 v38, v5 offset:5632
    ds_read_b32 v39, v5 offset:5888
    ds_read_b32 v40, v5 offset:6144
    ds_read_b32 v41, v5 offset:6400
    ds_read_b32 v42, v5 offset:6656
    ds_read_b32 v43, v5 offset:6912
    ds_read_b32 v44, v5 offset:7168
    ds_read_b32 v45, v5 offset:7424
    ds_read_b32 v46, v5 offset:7680
    ds_read_b32 v47, v5 offset:7936
    s_waitcnt lgkmcnt(0)
    v_pk_add_f32 v[16:17], v[16:17], v[32:33]
    v_pk_add_f32 v[18:19], v[18:19], v[34:35]
    v_pk_add_f32 v[20:21], v[20:21], v[36:37]
    v_pk_add_f32 v[22:23], v[22:23], v[38:39]
    v_pk_add_f32 v[24:25], v[24:25], v[40:41]
    v_pk_add_f32 v[26:27], v[26:27], v[42:43]
    v_pk_add_f32 v[28:29], v[28:29], v[44:45]
    v_pk_add_f32 v[30:31], v[30:31], v[46:47]
    v_pk_add_f32 v[16:17], v[16:17], v[24:25]
    v_pk_add_f32 v[18:19], v[18:19], v[26:27]
    v_pk_add_f32 v[20:21], v[20:21], v[28:29]
    v_pk_add_f32 v[22:23], v[22:23], v[30:31]
    v_pk_add_f32 v[16:17], v[16:17], v[20:21]
    v_pk_add_f32 v[18:19], v[18:19], v[22:23]
    v_pk_add_f32 v[16:17], v[16:17], v[18:19]
    v_add_f32 v16, v16, v17
    s_lshl_b32 s20, s3, 8
    s_add_u32 s20, s20, 25296896
    buffer_store_dword v16, v5, s[16:19], s20 offen
    s_endpgm
prep_kgen:
    s_cmp_ge_u32 s2, 640
    s_cbranch_scc1 prep_cs
    s_sub_u32 s3, s2, 128
    s_load_dwordx4 s[4:7], s[0:1], 8
    s_load_dwordx4 s[8:11], s[0:1], 24
    s_load_dwordx4 s[12:15], s[0:1], 40
    s_load_dwordx2 s[16:17], s[0:1], 56
    s_load_dwordx2 s[18:19], s[0:1], 112
    v_and_b32 v1, 127, v0
    s_lshl_b32 s20, s3, 8
    v_lshl_add_u32 v2, v1, 1, s20
    s_lshl_b32 s21, s3, 1
    v_mov_b32 v3, s21
    s_waitcnt lgkmcnt(0)
    global_load_ushort v4, v2, s[4:5]
    global_load_ushort v5, v2, s[6:7]
    global_load_ushort v6, v2, s[8:9]
    global_load_ushort v7, v2, s[10:11]
    global_load_ushort v8, v2, s[12:13]
    global_load_ushort v9, v2, s[14:15]
    global_load_ushort v10, v3, s[16:17]
    s_mov_b32 s24, s18
    s_and_b32 s25, s19, 0xffff
    s_mov_b32 s26, 0x10000000
    s_mov_b32 s27, 0x00020000
    s_cmp_lg_u32 s3, 5
    s_cbranch_scc1 prep_noconst
    v_mov_b32 v16, 0x3f803f80
    v_mov_b32 v17, 0x3f803f80
    v_mov_b32 v18, 0x3f803f80
    v_mov_b32 v19, 0x3f803f80
    v_mov_b32 v20, 0
    v_mov_b32 v21, 0
    v_mov_b32 v22, 0
    v_mov_b32 v23, 0
    v_lshlrev_b32 v11, 4, v0
    s_mov_b32 s22, 27262976
    s_mov_b32 s23, 27267072
    s_mov_b32 s28, 27271168
    buffer_store_dwordx4 v[16:19], v11, s[24:27], s22 offen
    buffer_store_dwordx4 v[16:19], v11, s[24:27], s23 offen
    buffer_store_dwordx4 v[16:19], v11, s[24:27], s28 offen
    v_add_u32 v11, 0x4000, v11
    buffer_store_dwordx4 v[20:23], v11, s[24:27], s22 offen
    buffer_store_dwordx4 v[20:23], v11, s[24:27], s23 offen
    buffer_store_dwordx4 v[20:23], v11, s[24:27], s28 offen
prep_noconst:
    s_mov_b32 s31, 0
    s_mov_b32 s31, 1
    s_mov_b64 exec, 0
    s_branch prep_dry
prep_real:
    s_waitcnt vmcnt(0)
prep_dry:
    v_mov_b32 v80, 0
    v_mov_b32 v81, 0
    v_mov_b32 v82, 0
    v_mov_b32 v83, 0
    v_mov_b32 v84, 0
    v_mov_b32 v85, 0
    v_mov_b32 v86, 0
    v_mov_b32 v87, 0
    v_mov_b32 v88, 0
    v_mov_b32 v89, 0
    v_mov_b32 v90, 0
    v_mov_b32 v91, 0
    v_mov_b32 v92, 0
    v_mov_b32 v93, 0
    v_mov_b32 v94, 0
    v_mov_b32 v95, 0
    s_nop 0
    v_lshlrev_b32 v4, 16, v4
    v_lshlrev_b32 v5, 16, v5
    v_lshlrev_b32 v6, 16, v6
    v_lshlrev_b32 v7, 16, v7
    v_lshlrev_b32 v8, 16, v8
    v_lshlrev_b32 v9, 16, v9
    v_lshlrev_b32 v10, 16, v10
    v_mul_f32 v10, 0x3fb8aa3b, v10
    v_exp_f32 v10, v10
    s_nop 0
    v_cvt_pk_bf16_f32 v10, v10, v10
    v_lshlrev_b32 v10, 16, v10
    v_mul_f32 v12, v10, v4
    v_mul_f32 v12, 0x3fb8aa3b, v12
    v_mul_f32 v13, v10, v5
    v_mul_f32 v13, 0x3e22f983, v13
    v_mul_f32 v6, v10, v6
    v_mul_f32 v7, v10, v7
    v_mul_f32 v14, v8, v6
    v_fma_f32 v14, -v9, v7, v14
    v_mul_f32 v15, v8, v7
    v_fma_f32 v15, v9, v6, v15
    v_mul_f32 v16, 0x43800000, v12
    v_mul_f32 v17, 0x43800000, v13
    v_exp_f32 v16, v16
    v_fract_f32 v17, v17
    v_sub_f32 v21, 0, v15
    v_sin_f32 v19, v17
    v_cos_f32 v18, v17
    v_mov_b32 v20, v14
    v_sub_f32 v23, 0, v14
    v_mov_b32 v22, v21
    v_mul_f32 v15, v19, v16
    v_mul_f32 v14, v18, v16
    v_lshlrev_b32 v2, 5, v1
    ds_write_b128 v2, v[12:15] offset:13312
    ds_write_b128 v2, v[20:23] offset:13328
    v_and_b32 v2, 3, v0
    v_lshlrev_b32 v2, 2, v2
    v_mov_b32 v3, 0
    ds_write_b32 v2, v3
    v_lshrrev_b32 v16, 6, v0
    v_and_b32 v17, 15, v0
    v_bfe_u32 v18, v0, 4, 2
    v_cvt_f32_u32 v21, v17
    v_mul_f32 v20, 0x41800000, v21
    v_lshlrev_b32 v19, 10, v16
    v_lshl_add_u32 v19, v18, 5, v19
    v_lshlrev_b32 v22, 10, v18
    v_lshl_add_u32 v22, v17, 4, v22
    v_lshl_add_u32 v22, v16, 2, v22
    s_waitcnt lgkmcnt(0)
    s_barrier
    ds_read_b128 v[24:27], v19 offset:13312
    ds_read_b128 v[28:31], v19 offset:13328
    s_cmp_eq_u32 s31, 1
    s_mov_b32 s31, 0
    s_mov_b64 exec, -1
    s_cbranch_scc1 prep_real
    s_mov_b32 s30, 4
prep_loop:
    ds_read_b128 v[32:35], v19 offset:13440
    ds_read_b128 v[36:39], v19 offset:13456
    s_waitcnt lgkmcnt(2)
    v_pk_mul_f32 v[40:41], v[20:21], v[24:25] op_sel:[0,0] op_sel_hi:[1,0]
    v_pk_mul_f32 v[42:43], v[20:21], v[24:25] op_sel:[0,1] op_sel_hi:[1,1]
    v_exp_f32 v40, v40
    v_exp_f32 v41, v41
    v_fract_f32 v42, v42
    v_fract_f32 v43, v43
    v_sin_f32 v44, v42
    v_sin_f32 v45, v43
    v_cos_f32 v46, v42
    v_cos_f32 v47, v43
    s_nop 0
    v_pk_mul_f32 v[66:67], v[44:45], v[40:41]
    v_pk_mul_f32 v[64:65], v[46:47], v[40:41]
    v_pk_mul_f32 v[56:57], v[28:29], v[64:65] op_sel:[0,0] op_sel_hi:[1,0]
    v_pk_fma_f32 v[56:57], v[30:31], v[66:67], v[56:57] op_sel:[0,0,0] op_sel_hi:[1,0,1]
    v_pk_mul_f32 v[52:53], v[66:67], v[66:67]
    v_pk_add_f32 v[54:55], v[64:65], v[64:65]
    v_pk_fma_f32 v[68:69], v[64:65], v[64:65], v[52:53] neg_lo:[0,0,1] neg_hi:[0,0,1]
    v_pk_mul_f32 v[70:71], v[54:55], v[66:67]
    v_mul_f32 v52, v70, v27
    v_mul_f32 v53, v70, v26
    v_fma_f32 v70, v68, v27, v53
    v_fma_f32 v68, v68, v26, -v52
    v_mfma_f32_16x16x4_f32 v[80:83], v56, v65, v[80:83]
    v_mfma_f32_16x16x4_f32 v[80:83], v57, v67, v[80:83]
    v_pk_mul_f32 v[58:59], v[28:29], v[68:69] op_sel:[0,0] op_sel_hi:[1,0]
    v_pk_fma_f32 v[58:59], v[30:31], v[70:71], v[58:59] op_sel:[0,0,0] op_sel_hi:[1,0,1]
    v_pk_mul_f32 v[52:53], v[70:71], v[70:71]
    v_pk_add_f32 v[54:55], v[68:69], v[68:69]
    v_pk_fma_f32 v[72:73], v[68:69], v[68:69], v[52:53] neg_lo:[0,0,1] neg_hi:[0,0,1]
    v_pk_mul_f32 v[74:75], v[54:55], v[70:71]
    v_mfma_f32_16x16x4_f32 v[84:87], v58, v69, v[84:87]
    v_mfma_f32_16x16x4_f32 v[84:87], v59, v71, v[84:87]
    v_pk_mul_f32 v[60:61], v[28:29], v[72:73] op_sel:[0,0] op_sel_hi:[1,0]
    v_pk_fma_f32 v[60:61], v[30:31], v[74:75], v[60:61] op_sel:[0,0,0] op_sel_hi:[1,0,1]
    v_pk_mul_f32 v[52:53], v[74:75], v[74:75]
    v_pk_add_f32 v[54:55], v[72:73], v[72:73]
    v_pk_fma_f32 v[76:77], v[72:73], v[72:73], v[52:53] neg_lo:[0,0,1] neg_hi:[0,0,1]
    v_pk_mul_f32 v[78:79], v[54:55], v[74:75]
    v_mfma_f32_16x16x4_f32 v[88:91], v60, v73, v[88:91]
    v_mfma_f32_16x16x4_f32 v[88:91], v61, v75, v[88:91]
    v_pk_mul_f32 v[62:63], v[28:29], v[76:77] op_sel:[0,0] op_sel_hi:[1,0]
    v_pk_fma_f32 v[62:63], v[30:31], v[78:79], v[62:63] op_sel:[0,0,0] op_sel_hi:[1,0,1]
    s_nop 1
    v_mfma_f32_16x16x4_f32 v[92:95], v62, v77, v[92:95]
    v_mfma_f32_16x16x4_f32 v[92:95], v63, v79, v[92:95]
    ds_read_b128 v[24:27], v19 offset:13568
    ds_read_b128 v[28:31], v19 offset:13584
    s_waitcnt lgkmcnt(2)
    v_add_u32 v19, 256, v19
    v_pk_mul_f32 v[40:41], v[20:21], v[32:33] op_sel:[0,0] op_sel_hi:[1,0]
    v_pk_mul_f32 v[42:43], v[20:21], v[32:33] op_sel:[0,1] op_sel_hi:[1,1]
    v_exp_f32 v40, v40
    v_exp_f32 v41, v41
    v_fract_f32 v42, v42
    v_fract_f32 v43, v43
    v_sin_f32 v44, v42
    v_sin_f32 v45, v43
    v_cos_f32 v46, v42
    v_cos_f32 v47, v43
    s_nop 0
    v_pk_mul_f32 v[66:67], v[44:45], v[40:41]
    v_pk_mul_f32 v[64:65], v[46:47], v[40:41]
    v_pk_mul_f32 v[56:57], v[36:37], v[64:65] op_sel:[0,0] op_sel_hi:[1,0]
    v_pk_fma_f32 v[56:57], v[38:39], v[66:67], v[56:57] op_sel:[0,0,0] op_sel_hi:[1,0,1]
    v_pk_mul_f32 v[52:53], v[66:67], v[66:67]
    v_pk_add_f32 v[54:55], v[64:65], v[64:65]
    v_pk_fma_f32 v[68:69], v[64:65], v[64:65], v[52:53] neg_lo:[0,0,1] neg_hi:[0,0,1]
    v_pk_mul_f32 v[70:71], v[54:55], v[66:67]
    v_mul_f32 v52, v70, v35
    v_mul_f32 v53, v70, v34
    v_fma_f32 v70, v68, v35, v53
    v_fma_f32 v68, v68, v34, -v52
    v_mfma_f32_16x16x4_f32 v[80:83], v56, v65, v[80:83]
    v_mfma_f32_16x16x4_f32 v[80:83], v57, v67, v[80:83]
    v_pk_mul_f32 v[58:59], v[36:37], v[68:69] op_sel:[0,0] op_sel_hi:[1,0]
    v_pk_fma_f32 v[58:59], v[38:39], v[70:71], v[58:59] op_sel:[0,0,0] op_sel_hi:[1,0,1]
    v_pk_mul_f32 v[52:53], v[70:71], v[70:71]
    v_pk_add_f32 v[54:55], v[68:69], v[68:69]
    v_pk_fma_f32 v[72:73], v[68:69], v[68:69], v[52:53] neg_lo:[0,0,1] neg_hi:[0,0,1]
    v_pk_mul_f32 v[74:75], v[54:55], v[70:71]
    v_mfma_f32_16x16x4_f32 v[84:87], v58, v69, v[84:87]
    v_mfma_f32_16x16x4_f32 v[84:87], v59, v71, v[84:87]
    v_pk_mul_f32 v[60:61], v[36:37], v[72:73] op_sel:[0,0] op_sel_hi:[1,0]
    v_pk_fma_f32 v[60:61], v[38:39], v[74:75], v[60:61] op_sel:[0,0,0] op_sel_hi:[1,0,1]
    v_pk_mul_f32 v[52:53], v[74:75], v[74:75]
    v_pk_add_f32 v[54:55], v[72:73], v[72:73]
    v_pk_fma_f32 v[76:77], v[72:73], v[72:73], v[52:53] neg_lo:[0,0,1] neg_hi:[0,0,1]
    v_pk_mul_f32 v[78:79], v[54:55], v[74:75]
    v_mfma_f32_16x16x4_f32 v[88:91], v60, v73, v[88:91]
    v_mfma_f32_16x16x4_f32 v[88:91], v61, v75, v[88:91]
    v_pk_mul_f32 v[62:63], v[36:37], v[76:77] op_sel:[0,0] op_sel_hi:[1,0]
    v_pk_fma_f32 v[62:63], v[38:39], v[78:79], v[62:63] op_sel:[0,0,0] op_sel_hi:[1,0,1]
    s_nop 1
    v_mfma_f32_16x16x4_f32 v[92:95], v62, v77, v[92:95]
    v_mfma_f32_16x16x4_f32 v[92:95], v63, v79, v[92:95]
    s_sub_u32 s30, s30, 1
    s_cmp_lg_u32 s30, 0
    s_cbranch_scc1 prep_loop
prep_tail:
    s_waitcnt lgkmcnt(0)
    v_lshlrev_b32 v1, 3, v0
    v_sub_u32 v1, 2047, v1
    v_cmp_gt_u32 vcc, 2, v18
    s_nop 7
    ds_write_b32 v22, v80 offset:16
    ds_write_b32 v22, v81 offset:272
    ds_write_b32 v22, v82 offset:528
    ds_write_b32 v22, v83 offset:784
    ds_write_b32 v22, v92 offset:8208
    ds_write_b32 v22, v93 offset:8464
    ds_write_b32 v22, v94 offset:8720
    ds_write_b32 v22, v95 offset:8976
    s_and_saveexec_b64 s[28:29], vcc
    ds_write_b32 v22, v84 offset:4112
    ds_write_b32 v22, v85 offset:4368
    ds_write_b32 v22, v86 offset:4624
    ds_write_b32 v22, v87 offset:4880
    ds_write_b32 v22, v88 offset:6160
    ds_write_b32 v22, v89 offset:6416
    ds_write_b32 v22, v90 offset:6672
    ds_write_b32 v22, v91 offset:6928
    s_mov_b64 exec, s[28:29]
    v_subrev_u32 v24, 0, v1
    v_max_i32 v34, 0, v24
    v_cvt_f32_u32 v34, v34
    v_min_i32 v24, 127, v24
    v_subrev_u32 v25, 1, v1
    v_max_i32 v35, 0, v25
    v_cvt_f32_u32 v35, v35
    v_min_i32 v25, 127, v25
    v_subrev_u32 v26, 2, v1
    v_max_i32 v36, 0, v26
    v_cvt_f32_u32 v36, v36
    v_min_i32 v26, 127, v26
    v_subrev_u32 v27, 3, v1
    v_max_i32 v37, 0, v27
    v_cvt_f32_u32 v37, v37
    v_min_i32 v27, 127, v27
    v_subrev_u32 v28, 4, v1
    v_max_i32 v38, 0, v28
    v_cvt_f32_u32 v38, v38
    v_min_i32 v28, 127, v28
    v_subrev_u32 v29, 5, v1
    v_max_i32 v39, 0, v29
    v_cvt_f32_u32 v39, v39
    v_min_i32 v29, 127, v29
    v_subrev_u32 v30, 6, v1
    v_max_i32 v40, 0, v30
    v_cvt_f32_u32 v40, v40
    v_min_i32 v30, 127, v30
    v_subrev_u32 v31, 7, v1
    v_max_i32 v41, 0, v31
    v_cvt_f32_u32 v41, v41
    v_min_i32 v31, 127, v31
    v_subrev_u32 v32, 8, v1
    v_max_i32 v42, 0, v32
    v_cvt_f32_u32 v42, v42
    v_min_i32 v32, 127, v32
    v_cvt_pk_bf16_f32 v34, v34, v35
    v_lshrrev_b32 v35, 16, v34
    v_and_b32 v34, 0xffff, v34
    v_cvt_pk_bf16_f32 v36, v36, v37
    v_lshrrev_b32 v37, 16, v36
    v_and_b32 v36, 0xffff, v36
    v_cvt_pk_bf16_f32 v38, v38, v39
    v_lshrrev_b32 v39, 16, v38
    v_and_b32 v38, 0xffff, v38
    v_cvt_pk_bf16_f32 v40, v40, v41
    v_lshrrev_b32 v41, 16, v40
    v_and_b32 v40, 0xffff, v40
    v_cvt_pk_bf16_f32 v42, v42, v42
    v_and_b32 v42, 0xffff, v42
    v_subrev_u32 v34, 17024, v34
    v_max_i32 v24, v24, v34
    v_lshlrev_b32 v24, 4, v24
    v_subrev_u32 v35, 17024, v35
    v_max_i32 v25, v25, v35
    v_lshlrev_b32 v25, 4, v25
    v_subrev_u32 v36, 17024, v36
    v_max_i32 v26, v26, v36
    v_lshlrev_b32 v26, 4, v26
    v_subrev_u32 v37, 17024, v37
    v_max_i32 v27, v27, v37
    v_lshlrev_b32 v27, 4, v27
    v_subrev_u32 v38, 17024, v38
    v_max_i32 v28, v28, v38
    v_lshlrev_b32 v28, 4, v28
    v_subrev_u32 v39, 17024, v39
    v_max_i32 v29, v29, v39
    v_lshlrev_b32 v29, 4, v29
    v_subrev_u32 v40, 17024, v40
    v_max_i32 v30, v30, v40
    v_lshlrev_b32 v30, 4, v30
    v_subrev_u32 v41, 17024, v41
    v_max_i32 v31, v31, v41
    v_lshlrev_b32 v31, 4, v31
    v_subrev_u32 v42, 17024, v42
    v_max_i32 v32, v32, v42
    v_lshlrev_b32 v32, 4, v32
    s_waitcnt lgkmcnt(0)
    s_barrier
    ds_read_b128 v[44:47], v24 offset:16
    ds_read_b128 v[48:51], v25 offset:16
    ds_read_b128 v[52:55], v26 offset:16
    ds_read_b128 v[56:59], v27 offset:16
    ds_read_b128 v[60:63], v28 offset:16
    ds_read_b128 v[64:67], v29 offset:16
    ds_read_b128 v[68:71], v30 offset:16
    ds_read_b128 v[72:75], v31 offset:16
    ds_read_b128 v[76:79], v32 offset:16
    s_waitcnt lgkmcnt(8)
    v_pk_add_f32 v[44:45], v[44:45], v[46:47]
    v_add_f32 v24, v44, v45
    s_waitcnt lgkmcnt(7)
    v_pk_add_f32 v[48:49], v[48:49], v[50:51]
    v_add_f32 v25, v48, v49
    s_waitcnt lgkmcnt(6)
    v_pk_add_f32 v[52:53], v[52:53], v[54:55]
    v_add_f32 v26, v52, v53
    s_waitcnt lgkmcnt(5)
    v_pk_add_f32 v[56:57], v[56:57], v[58:59]
    v_add_f32 v27, v56, v57
    s_waitcnt lgkmcnt(4)
    v_pk_add_f32 v[60:61], v[60:61], v[62:63]
    v_add_f32 v28, v60, v61
    s_waitcnt lgkmcnt(3)
    v_pk_add_f32 v[64:65], v[64:65], v[66:67]
    v_add_f32 v29, v64, v65
    s_waitcnt lgkmcnt(2)
    v_pk_add_f32 v[68:69], v[68:69], v[70:71]
    v_add_f32 v30, v68, v69
    s_waitcnt lgkmcnt(1)
    v_pk_add_f32 v[72:73], v[72:73], v[74:75]
    v_add_f32 v31, v72, v73
    s_waitcnt lgkmcnt(0)
    v_pk_add_f32 v[76:77], v[76:77], v[78:79]
    v_add_f32 v32, v76, v77
    s_mul_i32 s20, s3, 8448
    s_add_u32 s20, s20, 8388608
    v_lshlrev_b32 v1, 4, v0
    s_waitcnt lgkmcnt(0)
    v_cvt_pk_bf16_f32 v8, v24, v25
    v_cvt_pk_bf16_f32 v9, v26, v27
    v_cvt_pk_bf16_f32 v10, v28, v29
    v_cvt_pk_bf16_f32 v11, v30, v31
    v_cvt_pk_bf16_f32 v12, v25, v26
    v_cvt_pk_bf16_f32 v13, v27, v28
    v_cvt_pk_bf16_f32 v14, v29, v30
    v_cvt_pk_bf16_f32 v15, v31, v32
    s_add_u32 s21, s20, 4224
    buffer_store_dwordx4 v[8:11], v1, s[24:27], s20 offen
    buffer_store_dwordx4 v[12:15], v1, s[24:27], s21 offen
    v_lshrrev_b32 v2, 3, v0
    v_mul_u32_u24 v2, 4224, v2
    v_and_b32 v3, 7, v0
    v_lshl_add_u32 v2, v3, 4, v2
    v_add_u32 v2, 4096, v2
    v_mov_b32 v16, 0
    v_mov_b32 v17, 0
    v_mov_b32 v18, 0
    v_mov_b32 v19, 0
    v_cmp_gt_u32 vcc, 16, v0
    s_and_saveexec_b64 s[28:29], vcc
    s_cbranch_execz prep_kgen_done
    buffer_store_dwordx4 v[16:19], v2, s[24:27], s20 offen

prep_kgen_done:
prep_kernel_end:
    s_endpgm
.globl conv2_kernel
.p2align 8
.type conv2_kernel,@function
conv2_kernel:
    s_load_dwordx2 s[4:5], s[0:1], 112
    s_load_dwordx2 s[6:7], s[0:1], 64
    s_cmp_ge_u32 s2, 256
    s_cbranch_scc1 conv1_kernel_end
    s_mov_b32 s40, 4194304
    s_mov_b32 s41, 6291456
    s_mov_b32 s16, 25231360
    s_branch conv1_kernel_body
.globl conv1_kernel
.p2align 8
.type conv1_kernel,@function
conv1_kernel:
    s_load_dwordx2 s[4:5], s[0:1], 112
    s_load_dwordx2 s[6:7], s[0:1], 64
    s_cmp_ge_u32 s2, 256
    s_cbranch_scc1 conv1_kernel_end
    s_mov_b32 s40, 0
    s_mov_b32 s41, 2097152
    s_mov_b32 s16, 25165824
conv1_kernel_body:
    s_and_b32 s3, s2, 1
    s_lshl_b32 s3, s3, 7
    s_bfe_u32 s12, s2, 0x20001
    s_add_u32 s3, s3, s12
    s_lshr_b32 s12, s2, 3
    s_lshl_b32 s12, s12, 2
    s_add_u32 s2, s3, s12
    s_mul_i32 s12, s2, 16896
    s_add_u32 s12, s12, 8388608
    s_lshl_b32 s13, s2, 13
    s_add_u32 s14, s13, s41
    s_add_u32 s13, s13, s40
    s_add_u32 s15, s13, 4096
    v_lshlrev_b32 v1, 4, v0
    v_lshlrev_b32 v2, 6, v0
    s_mov_b32 s10, 0x10000000
    s_mov_b32 s11, 0x00020000
    s_waitcnt lgkmcnt(0)
    s_mov_b32 s8, s4
    s_and_b32 s9, s5, 0xffff
    buffer_load_dwordx4 v[100:103], v1, s[8:11], s13 offen
    buffer_load_dwordx4 v[104:107], v1, s[8:11], s15 offen
    buffer_load_dwordx4 v[108:111], v2, s[8:11], s16 offen
    buffer_load_dwordx4 v[112:115], v2, s[8:11], s16 offen offset:16
    buffer_load_dwordx4 v[116:119], v2, s[8:11], s16 offen offset:32
    buffer_load_dwordx4 v[120:123], v2, s[8:11], s16 offen offset:48
    s_add_u32 s17, s12, 0
    buffer_load_dwordx4 v[4:7], v1, s[8:11], s17 offen
    s_add_u32 s17, s12, 4224
    buffer_load_dwordx4 v[8:11], v1, s[8:11], s17 offen
    s_add_u32 s17, s12, 8448
    buffer_load_dwordx4 v[12:15], v1, s[8:11], s17 offen
    s_add_u32 s17, s12, 12672
    buffer_load_dwordx4 v[16:19], v1, s[8:11], s17 offen
    v_lshrrev_b32 v70, 7, v0
    s_lshl_b32 s17, s2, 2
    v_lshl_add_u32 v71, v70, 1, s17
    s_waitcnt lgkmcnt(0)
    global_load_ushort v72, v71, s[6:7]
    v_mov_b32 v124, 0
    v_mov_b32 v125, 0
    v_mov_b32 v126, 0
    v_mov_b32 v127, 0
    v_cmp_gt_u32 vcc, 155, v0
    s_and_saveexec_b64 s[20:21], vcc
    v_add_u32 v73, 68608, v1
    ds_write_b128 v73, v[124:127]
    ds_write_b128 v73, v[124:127] offset:7680
    s_mov_b64 exec, s[20:21]
    v_lshrrev_b32 v73, 2, v0
    v_mul_u32_u24 v73, 4288, v73
    v_and_b32 v74, 3, v0
    v_lshl_add_u32 v73, v74, 4, v73
    v_cmp_gt_u32 vcc, 64, v0
    s_and_saveexec_b64 s[20:21], vcc
    ds_write_b128 v73, v[124:127] offset:4096
    v_mul_u32_u24 v75, 20, v74
    v_sub_u32 v75, v73, v75
    v_bfe_u32 v76, v0, 3, 2
    v_cmp_le_u32 vcc, v74, v76
    s_and_b64 exec, exec, vcc
    ds_write_b32 v75, v124 offset:4096
    s_mov_b64 exec, s[20:21]
    v_and_b32 v75, 31, v0
    v_bfe_u32 v76, v0, 5, 1
    v_bfe_u32 v77, v0, 6, 1
    v_sub_u32 v78, 7, v75
    v_and_b32 v78, 7, v78
    v_mul_u32_u24 v79, 34304, v70
    v_mul_u32_u24 v80, 4288, v78
    v_add_u32 v79, v79, v80
    v_lshlrev_b32 v80, 3, v76
    v_add_u32 v80, 2047, v80
    v_sub_u32 v80, v80, v75
    v_sub_u32 v80, v80, v78
    v_lshl_add_u32 v79, v80, 1, v79
    v_lshlrev_b32 v80, 6, v77
    v_sub_u32 v79, v79, v80
    v_subrev_u32 v79, 3968, v79
    v_mul_u32_u24 v80, 7680, v70
    v_sub_u32 v81, v75, v77
    v_mul_i32_i24 v81, 80, v81
    v_add3_u32 v80, v80, v81, 0
    v_lshl_add_u32 v80, v76, 4, v80
    v_add_u32 v80, 68608, v80
    v_mov_b32 v128, 0
    v_mov_b32 v129, 0
    v_mov_b32 v130, 0
    v_mov_b32 v131, 0
    v_mov_b32 v132, 0
    v_mov_b32 v133, 0
    v_mov_b32 v134, 0
    v_mov_b32 v135, 0
    v_mov_b32 v136, 0
    v_mov_b32 v137, 0
    v_mov_b32 v138, 0
    v_mov_b32 v139, 0
    v_mov_b32 v140, 0
    v_mov_b32 v141, 0
    v_mov_b32 v142, 0
    v_mov_b32 v143, 0
    v_mov_b32 v144, 0
    v_mov_b32 v145, 0
    v_mov_b32 v146, 0
    v_mov_b32 v147, 0
    v_mov_b32 v148, 0
    v_mov_b32 v149, 0
    v_mov_b32 v150, 0
    v_mov_b32 v151, 0
    v_mov_b32 v152, 0
    v_mov_b32 v153, 0
    v_mov_b32 v154, 0
    v_mov_b32 v155, 0
    v_mov_b32 v156, 0
    v_mov_b32 v157, 0
    v_mov_b32 v158, 0
    v_mov_b32 v159, 0
    v_and_b32 v82, 63, v0
    v_lshlrev_b32 v82, 4, v82
    v_lshl_add_u32 v82, v70, 13, v82
    v_add_u32 v82, 83968, v82
    v_lshl_add_u32 v83, v77, 12, v82
    v_xor_b32 v84, 4096, v83
    v_lshlrev_b32 v85, 5, v77
    v_add_u32 v85, v85, v75
    v_lshlrev_b32 v86, 6, v85
    v_lshl_add_u32 v86, v76, 3, v86
    v_lshl_add_u32 v86, v70, 12, v86
    v_add_u32 v87, 31, v85
    v_mul_u32_u24 v87, 80, v87
    v_lshl_add_u32 v87, v76, 3, v87
    v_mul_u32_u24 v88, 7680, v70
    v_add_u32 v87, v87, v88
    v_add_u32 v87, 68608, v87
    s_waitcnt vmcnt(5)
    v_mul_f32 v108, 0x3b000000, v108
    v_mul_f32 v109, 0x3b000000, v109
    v_fma_f32 v109, -v108, v108, v109
    v_max_f32 v109, 0, v109
    s_waitcnt vmcnt(4)
    ds_write_b128 v1, v[4:7] offset:0
    v_cvt_pk_bf16_f32 v124, v108, v109
    v_lshlrev_b32 v108, 16, v124
    v_and_b32 v109, 0xffff0000, v124
    v_add_f32 v109, 0x3727c5ac, v109
    v_cvt_pk_bf16_f32 v124, v109, v109
    v_lshlrev_b32 v109, 16, v124
    v_sqrt_f32 v109, v109
    s_nop 0
    v_cvt_pk_bf16_f32 v124, v109, v109
    v_lshlrev_b32 v109, 16, v124
    v_rcp_f32 v109, v109
    s_nop 0
    v_add_u32 v22, 8572, v1
    ds_write2_b32 v22, v4, v5 offset0:0 offset1:1
    ds_write2_b32 v22, v6, v7 offset0:2 offset1:3
    v_mul_f32 v110, 0x3b000000, v110
    v_mul_f32 v111, 0x3b000000, v111
    v_fma_f32 v111, -v110, v110, v111
    v_max_f32 v111, 0, v111
    v_cvt_pk_bf16_f32 v124, v110, v111
    v_lshlrev_b32 v110, 16, v124
    v_and_b32 v111, 0xffff0000, v124
    v_add_f32 v111, 0x3727c5ac, v111
    v_cvt_pk_bf16_f32 v124, v111, v111
    v_lshlrev_b32 v111, 16, v124
    v_sqrt_f32 v111, v111
    s_nop 0
    ds_write_b64 v1, v[4:5] offset:17144
    ds_write_b64 v1, v[6:7] offset:17152
    v_cvt_pk_bf16_f32 v124, v111, v111
    v_lshlrev_b32 v111, 16, v124
    v_rcp_f32 v111, v111
    s_nop 0
    v_mul_f32 v112, 0x3b000000, v112
    v_mul_f32 v113, 0x3b000000, v113
    v_fma_f32 v113, -v112, v112, v113
    v_max_f32 v113, 0, v113
    v_cvt_pk_bf16_f32 v124, v112, v113
    v_lshlrev_b32 v112, 16, v124
    v_and_b32 v113, 0xffff0000, v124
    v_add_f32 v113, 0x3727c5ac, v113
    v_add_u32 v26, 25716, v1
    ds_write2_b32 v26, v4, v5 offset0:0 offset1:1
    ds_write2_b32 v26, v6, v7 offset0:2 offset1:3
    v_cvt_pk_bf16_f32 v124, v113, v113
    v_lshlrev_b32 v113, 16, v124
    v_sqrt_f32 v113, v113
    s_nop 0
    v_cvt_pk_bf16_f32 v124, v113, v113
    v_lshlrev_b32 v113, 16, v124
    v_rcp_f32 v113, v113
    s_nop 0
    v_mul_f32 v114, 0x3b000000, v114
    v_mul_f32 v115, 0x3b000000, v115
    v_fma_f32 v115, -v114, v114, v115
    v_max_f32 v115, 0, v115
    s_waitcnt vmcnt(3)
    ds_write_b128 v1, v[8:11] offset:4288
    v_cvt_pk_bf16_f32 v124, v114, v115
    v_lshlrev_b32 v114, 16, v124
    v_and_b32 v115, 0xffff0000, v124
    v_add_f32 v115, 0x3727c5ac, v115
    v_cvt_pk_bf16_f32 v124, v115, v115
    v_lshlrev_b32 v115, 16, v124
    v_sqrt_f32 v115, v115
    s_nop 0
    v_cvt_pk_bf16_f32 v124, v115, v115
    v_lshlrev_b32 v115, 16, v124
    v_rcp_f32 v115, v115
    s_nop 0
    v_add_u32 v23, 12860, v1
    ds_write2_b32 v23, v8, v9 offset0:0 offset1:1
    ds_write2_b32 v23, v10, v11 offset0:2 offset1:3
    v_mul_f32 v116, 0x3b000000, v116
    v_mul_f32 v117, 0x3b000000, v117
    v_fma_f32 v117, -v116, v116, v117
    v_max_f32 v117, 0, v117
    v_cvt_pk_bf16_f32 v124, v116, v117
    v_lshlrev_b32 v116, 16, v124
    v_and_b32 v117, 0xffff0000, v124
    v_add_f32 v117, 0x3727c5ac, v117
    v_cvt_pk_bf16_f32 v124, v117, v117
    v_lshlrev_b32 v117, 16, v124
    v_sqrt_f32 v117, v117
    s_nop 0
    ds_write_b64 v1, v[8:9] offset:21432
    ds_write_b64 v1, v[10:11] offset:21440
    v_cvt_pk_bf16_f32 v124, v117, v117
    v_lshlrev_b32 v117, 16, v124
    v_rcp_f32 v117, v117
    s_nop 0
    v_mul_f32 v118, 0x3b000000, v118
    v_mul_f32 v119, 0x3b000000, v119
    v_fma_f32 v119, -v118, v118, v119
    v_max_f32 v119, 0, v119
    v_cvt_pk_bf16_f32 v124, v118, v119
    v_lshlrev_b32 v118, 16, v124
    v_and_b32 v119, 0xffff0000, v124
    v_add_f32 v119, 0x3727c5ac, v119
    v_add_u32 v27, 30004, v1
    ds_write2_b32 v27, v8, v9 offset0:0 offset1:1
    ds_write2_b32 v27, v10, v11 offset0:2 offset1:3
    v_cvt_pk_bf16_f32 v124, v119, v119
    v_lshlrev_b32 v119, 16, v124
    v_sqrt_f32 v119, v119
    s_nop 0
    v_cvt_pk_bf16_f32 v124, v119, v119
    v_lshlrev_b32 v119, 16, v124
    v_rcp_f32 v119, v119
    s_nop 0
    v_mul_f32 v120, 0x3b000000, v120
    v_mul_f32 v121, 0x3b000000, v121
    v_fma_f32 v121, -v120, v120, v121
    v_max_f32 v121, 0, v121
    s_waitcnt vmcnt(2)
    ds_write_b128 v1, v[12:15] offset:34304
    v_cvt_pk_bf16_f32 v124, v120, v121
    v_lshlrev_b32 v120, 16, v124
    v_and_b32 v121, 0xffff0000, v124
    v_add_f32 v121, 0x3727c5ac, v121
    v_cvt_pk_bf16_f32 v124, v121, v121
    v_lshlrev_b32 v121, 16, v124
    v_sqrt_f32 v121, v121
    s_nop 0
    v_cvt_pk_bf16_f32 v124, v121, v121
    v_lshlrev_b32 v121, 16, v124
    v_rcp_f32 v121, v121
    s_nop 0
    v_add_u32 v22, 42876, v1
    ds_write2_b32 v22, v12, v13 offset0:0 offset1:1
    ds_write2_b32 v22, v14, v15 offset0:2 offset1:3
    v_mul_f32 v122, 0x3b000000, v122
    v_mul_f32 v123, 0x3b000000, v123
    v_fma_f32 v123, -v122, v122, v123
    v_max_f32 v123, 0, v123
    v_cvt_pk_bf16_f32 v124, v122, v123
    v_lshlrev_b32 v122, 16, v124
    v_and_b32 v123, 0xffff0000, v124
    v_add_f32 v123, 0x3727c5ac, v123
    v_cvt_pk_bf16_f32 v124, v123, v123
    v_lshlrev_b32 v123, 16, v124
    v_sqrt_f32 v123, v123
    s_nop 0
    ds_write_b64 v1, v[12:13] offset:51448
    ds_write_b64 v1, v[14:15] offset:51456
    v_cvt_pk_bf16_f32 v124, v123, v123
    v_lshlrev_b32 v123, 16, v124
    v_rcp_f32 v123, v123
    s_nop 0
    v_lshlrev_b32 v124, 16, v100
    v_and_b32 v125, 0xffff0000, v100
    v_sub_f32 v124, v124, v108
    v_sub_f32 v125, v125, v110
    v_cvt_pk_bf16_f32 v126, v124, v125
    v_lshlrev_b32 v124, 16, v126
    v_and_b32 v125, 0xffff0000, v126
    v_mul_f32 v124, v124, v109
    v_add_u32 v26, 60020, v1
    ds_write2_b32 v26, v12, v13 offset0:0 offset1:1
    ds_write2_b32 v26, v14, v15 offset0:2 offset1:3
    v_mul_f32 v125, v125, v111
    v_cvt_pk_bf16_f32 v100, v124, v125
    v_lshlrev_b32 v124, 16, v101
    v_and_b32 v125, 0xffff0000, v101
    v_sub_f32 v124, v124, v112
    v_sub_f32 v125, v125, v114
    v_cvt_pk_bf16_f32 v126, v124, v125
    v_lshlrev_b32 v124, 16, v126
    v_and_b32 v125, 0xffff0000, v126
    v_mul_f32 v124, v124, v113
    v_mul_f32 v125, v125, v115
    v_cvt_pk_bf16_f32 v101, v124, v125
    s_waitcnt vmcnt(1)
    ds_write_b128 v1, v[16:19] offset:38592
    v_lshlrev_b32 v124, 16, v102
    v_and_b32 v125, 0xffff0000, v102
    v_sub_f32 v124, v124, v116
    v_sub_f32 v125, v125, v118
    v_cvt_pk_bf16_f32 v126, v124, v125
    v_lshlrev_b32 v124, 16, v126
    v_and_b32 v125, 0xffff0000, v126
    v_mul_f32 v124, v124, v117
    v_mul_f32 v125, v125, v119
    v_cvt_pk_bf16_f32 v102, v124, v125
    v_lshlrev_b32 v124, 16, v103
    v_and_b32 v125, 0xffff0000, v103
    v_add_u32 v23, 47164, v1
    ds_write2_b32 v23, v16, v17 offset0:0 offset1:1
    ds_write2_b32 v23, v18, v19 offset0:2 offset1:3
    v_sub_f32 v124, v124, v120
    v_sub_f32 v125, v125, v122
    v_cvt_pk_bf16_f32 v126, v124, v125
    v_lshlrev_b32 v124, 16, v126
    v_and_b32 v125, 0xffff0000, v126
    v_mul_f32 v124, v124, v121
    v_mul_f32 v125, v125, v123
    v_cvt_pk_bf16_f32 v103, v124, v125
    v_lshlrev_b32 v124, 16, v104
    v_and_b32 v125, 0xffff0000, v104
    v_sub_f32 v124, v124, v108
    v_sub_f32 v125, v125, v110
    ds_write_b64 v1, v[16:17] offset:55736
    ds_write_b64 v1, v[18:19] offset:55744
    v_cvt_pk_bf16_f32 v126, v124, v125
    v_lshlrev_b32 v124, 16, v126
    v_and_b32 v125, 0xffff0000, v126
    v_mul_f32 v124, v124, v109
    v_mul_f32 v125, v125, v111
    v_cvt_pk_bf16_f32 v104, v124, v125
    v_lshlrev_b32 v124, 16, v105
    v_and_b32 v125, 0xffff0000, v105
    v_sub_f32 v124, v124, v112
    v_sub_f32 v125, v125, v114
    v_cvt_pk_bf16_f32 v126, v124, v125
    v_lshlrev_b32 v124, 16, v126
    v_add_u32 v27, 64308, v1
    ds_write2_b32 v27, v16, v17 offset0:0 offset1:1
    ds_write2_b32 v27, v18, v19 offset0:2 offset1:3
    v_and_b32 v125, 0xffff0000, v126
    v_mul_f32 v124, v124, v113
    v_mul_f32 v125, v125, v115
    v_cvt_pk_bf16_f32 v105, v124, v125
    v_lshlrev_b32 v124, 16, v106
    v_and_b32 v125, 0xffff0000, v106
    v_sub_f32 v124, v124, v116
    v_sub_f32 v125, v125, v118
    v_cvt_pk_bf16_f32 v126, v124, v125
    v_lshlrev_b32 v124, 16, v126
    v_and_b32 v125, 0xffff0000, v126
    v_mul_f32 v124, v124, v117
    v_mul_f32 v125, v125, v119
    v_cvt_pk_bf16_f32 v106, v124, v125
    v_lshlrev_b32 v124, 16, v107
    v_and_b32 v125, 0xffff0000, v107
    v_sub_f32 v124, v124, v120
    v_sub_f32 v125, v125, v122
    v_cvt_pk_bf16_f32 v126, v124, v125
    v_lshlrev_b32 v124, 16, v126
    v_and_b32 v125, 0xffff0000, v126
    v_mul_f32 v124, v124, v121
    v_mul_f32 v125, v125, v123
    v_cvt_pk_bf16_f32 v107, v124, v125
    v_lshrrev_b32 v73, 2, v0
    v_mul_u32_u24 v73, 80, v73
    v_lshl_add_u32 v73, v74, 4, v73
    v_add_u32 v73, 71088, v73
    ds_write_b128 v73, v[100:103]
    ds_write_b128 v73, v[104:107] offset:7680
    s_waitcnt lgkmcnt(0)
    s_barrier
    buffer_load_dwordx2 v[28:29], v86, s[8:11], s13 offen offset:0
    ds_read_b64 v[12:13], v87 offset:0
    buffer_load_dwordx2 v[30:31], v86, s[8:11], s13 offen offset:16
    ds_read_b64 v[14:15], v87 offset:16
    buffer_load_dwordx2 v[32:33], v86, s[8:11], s13 offen offset:32
    ds_read_b64 v[16:17], v87 offset:32
    buffer_load_dwordx2 v[34:35], v86, s[8:11], s13 offen offset:48
    ds_read_b64 v[18:19], v87 offset:48
    ds_read_b128 v[160:163], v79 offset:3968
    ds_read_b128 v[176:179], v80 offset:5040
    ds_read_b128 v[168:171], v80 offset:2480
    ds_read_b128 v[164:167], v79 offset:4000
    ds_read_b128 v[180:183], v80 offset:5072
    ds_read_b128 v[172:175], v80 offset:2512
    ds_read_b128 v[184:187], v79 offset:3840
    ds_read_b128 v[200:203], v80 offset:4880
    ds_read_b128 v[192:195], v80 offset:2320
    ds_read_b128 v[188:191], v79 offset:3872
    ds_read_b128 v[204:207], v80 offset:4912
    ds_read_b128 v[196:199], v80 offset:2352
    s_waitcnt lgkmcnt(6)
    v_mfma_f32_32x32x16_bf16 v[144:159], v[160:163], v[176:179], v[144:159]
    ds_read_b128 v[208:211], v79 offset:3712
    ds_read_b128 v[224:227], v80 offset:4720
    v_mfma_f32_32x32x16_bf16 v[128:143], v[160:163], v[168:171], v[128:143]
    ds_read_b128 v[216:219], v80 offset:2160
    ds_read_b128 v[212:215], v79 offset:3744
    v_mfma_f32_32x32x16_bf16 v[144:159], v[164:167], v[180:183], v[144:159]
    ds_read_b128 v[228:231], v80 offset:4752
    ds_read_b128 v[220:223], v80 offset:2192
    v_mfma_f32_32x32x16_bf16 v[128:143], v[164:167], v[172:175], v[128:143]
    s_waitcnt lgkmcnt(6)
    v_mfma_f32_32x32x16_bf16 v[144:159], v[184:187], v[200:203], v[144:159]
    ds_read_b128 v[160:163], v79 offset:3584
    ds_read_b128 v[176:179], v80 offset:4560
    v_mfma_f32_32x32x16_bf16 v[128:143], v[184:187], v[192:195], v[128:143]
    ds_read_b128 v[168:171], v80 offset:2000
    ds_read_b128 v[164:167], v79 offset:3616
    v_mfma_f32_32x32x16_bf16 v[144:159], v[188:191], v[204:207], v[144:159]
    ds_read_b128 v[180:183], v80 offset:4592
    ds_read_b128 v[172:175], v80 offset:2032
    v_mfma_f32_32x32x16_bf16 v[128:143], v[188:191], v[196:199], v[128:143]
    s_waitcnt lgkmcnt(6)
    v_mfma_f32_32x32x16_bf16 v[144:159], v[208:211], v[224:227], v[144:159]
    ds_read_b128 v[184:187], v79 offset:3456
    ds_read_b128 v[200:203], v80 offset:4400
    v_mfma_f32_32x32x16_bf16 v[128:143], v[208:211], v[216:219], v[128:143]
    ds_read_b128 v[192:195], v80 offset:1840
    ds_read_b128 v[188:191], v79 offset:3488
    v_mfma_f32_32x32x16_bf16 v[144:159], v[212:215], v[228:231], v[144:159]
    ds_read_b128 v[204:207], v80 offset:4432
    ds_read_b128 v[196:199], v80 offset:1872
    v_mfma_f32_32x32x16_bf16 v[128:143], v[212:215], v[220:223], v[128:143]
    s_waitcnt lgkmcnt(6)
    v_mfma_f32_32x32x16_bf16 v[144:159], v[160:163], v[176:179], v[144:159]
    ds_read_b128 v[208:211], v79 offset:3328
    ds_read_b128 v[224:227], v80 offset:4240
    v_mfma_f32_32x32x16_bf16 v[128:143], v[160:163], v[168:171], v[128:143]
    ds_read_b128 v[216:219], v80 offset:1680
    ds_read_b128 v[212:215], v79 offset:3360
    v_mfma_f32_32x32x16_bf16 v[144:159], v[164:167], v[180:183], v[144:159]
    ds_read_b128 v[228:231], v80 offset:4272
    ds_read_b128 v[220:223], v80 offset:1712
    v_mfma_f32_32x32x16_bf16 v[128:143], v[164:167], v[172:175], v[128:143]
    s_waitcnt lgkmcnt(6)
    v_mfma_f32_32x32x16_bf16 v[144:159], v[184:187], v[200:203], v[144:159]
    ds_read_b128 v[160:163], v79 offset:3200
    ds_read_b128 v[176:179], v80 offset:4080
    v_mfma_f32_32x32x16_bf16 v[128:143], v[184:187], v[192:195], v[128:143]
    ds_read_b128 v[168:171], v80 offset:1520
    ds_read_b128 v[164:167], v79 offset:3232
    v_mfma_f32_32x32x16_bf16 v[144:159], v[188:191], v[204:207], v[144:159]
    ds_read_b128 v[180:183], v80 offset:4112
    ds_read_b128 v[172:175], v80 offset:1552
    v_mfma_f32_32x32x16_bf16 v[128:143], v[188:191], v[196:199], v[128:143]
    s_waitcnt lgkmcnt(6)
    v_mfma_f32_32x32x16_bf16 v[144:159], v[208:211], v[224:227], v[144:159]
    ds_read_b128 v[184:187], v79 offset:3072
    ds_read_b128 v[200:203], v80 offset:3920
    v_mfma_f32_32x32x16_bf16 v[128:143], v[208:211], v[216:219], v[128:143]
    ds_read_b128 v[192:195], v80 offset:1360
    ds_read_b128 v[188:191], v79 offset:3104
    v_mfma_f32_32x32x16_bf16 v[144:159], v[212:215], v[228:231], v[144:159]
    ds_read_b128 v[204:207], v80 offset:3952
    ds_read_b128 v[196:199], v80 offset:1392
    v_mfma_f32_32x32x16_bf16 v[128:143], v[212:215], v[220:223], v[128:143]
    s_waitcnt lgkmcnt(6)
    v_mfma_f32_32x32x16_bf16 v[144:159], v[160:163], v[176:179], v[144:159]
    ds_read_b128 v[208:211], v79 offset:2944
    ds_read_b128 v[224:227], v80 offset:3760
    s_waitcnt vmcnt(0)
    v_lshlrev_b32 v72, 16, v72
    v_mfma_f32_32x32x16_bf16 v[128:143], v[160:163], v[168:171], v[128:143]
    ds_read_b128 v[216:219], v80 offset:1200
    ds_read_b128 v[212:215], v79 offset:2976
    v_lshlrev_b32 v36, 16, v12
    v_and_b32 v37, 0xffff0000, v12
    v_mfma_f32_32x32x16_bf16 v[144:159], v[164:167], v[180:183], v[144:159]
    ds_read_b128 v[228:231], v80 offset:3792
    ds_read_b128 v[220:223], v80 offset:1232
    v_pk_mul_f32 v[36:37], v[36:37], v[72:73] op_sel:[0,0] op_sel_hi:[1,0]
    v_cvt_pk_bf16_f32 v60, v36, v37
    v_mfma_f32_32x32x16_bf16 v[128:143], v[164:167], v[172:175], v[128:143]
    v_lshlrev_b32 v36, 16, v60
    v_and_b32 v37, 0xffff0000, v60
    s_waitcnt lgkmcnt(6)
    v_mfma_f32_32x32x16_bf16 v[144:159], v[184:187], v[200:203], v[144:159]
    ds_read_b128 v[160:163], v79 offset:2816
    ds_read_b128 v[176:179], v80 offset:3600
    v_lshlrev_b32 v100, 16, v28
    v_and_b32 v101, 0xffff0000, v28
    v_mfma_f32_32x32x16_bf16 v[128:143], v[184:187], v[192:195], v[128:143]
    ds_read_b128 v[168:171], v80 offset:1040
    ds_read_b128 v[164:167], v79 offset:2848
    v_lshlrev_b32 v38, 16, v13
    v_and_b32 v39, 0xffff0000, v13
    v_mfma_f32_32x32x16_bf16 v[144:159], v[188:191], v[204:207], v[144:159]
    ds_read_b128 v[180:183], v80 offset:3632
    ds_read_b128 v[172:175], v80 offset:1072
    v_pk_mul_f32 v[38:39], v[38:39], v[72:73] op_sel:[0,0] op_sel_hi:[1,0]
    v_cvt_pk_bf16_f32 v60, v38, v39
    v_mfma_f32_32x32x16_bf16 v[128:143], v[188:191], v[196:199], v[128:143]
    v_lshlrev_b32 v38, 16, v60
    v_and_b32 v39, 0xffff0000, v60
    s_waitcnt lgkmcnt(6)
    v_mfma_f32_32x32x16_bf16 v[144:159], v[208:211], v[224:227], v[144:159]
    ds_read_b128 v[184:187], v79 offset:2688
    ds_read_b128 v[200:203], v80 offset:3440
    v_lshlrev_b32 v102, 16, v29
    v_and_b32 v103, 0xffff0000, v29
    v_mfma_f32_32x32x16_bf16 v[128:143], v[208:211], v[216:219], v[128:143]
    ds_read_b128 v[192:195], v80 offset:880
    ds_read_b128 v[188:191], v79 offset:2720
    v_lshlrev_b32 v40, 16, v14
    v_and_b32 v41, 0xffff0000, v14
    v_mfma_f32_32x32x16_bf16 v[144:159], v[212:215], v[228:231], v[144:159]
    ds_read_b128 v[204:207], v80 offset:3472
    ds_read_b128 v[196:199], v80 offset:912
    v_pk_mul_f32 v[40:41], v[40:41], v[72:73] op_sel:[0,0] op_sel_hi:[1,0]
    v_cvt_pk_bf16_f32 v60, v40, v41
    v_mfma_f32_32x32x16_bf16 v[128:143], v[212:215], v[220:223], v[128:143]
    v_lshlrev_b32 v40, 16, v60
    v_and_b32 v41, 0xffff0000, v60
    s_waitcnt lgkmcnt(6)
    v_mfma_f32_32x32x16_bf16 v[144:159], v[160:163], v[176:179], v[144:159]
    ds_read_b128 v[208:211], v79 offset:2560
    ds_read_b128 v[224:227], v80 offset:3280
    v_lshlrev_b32 v104, 16, v30
    v_and_b32 v105, 0xffff0000, v30
    v_mfma_f32_32x32x16_bf16 v[128:143], v[160:163], v[168:171], v[128:143]
    ds_read_b128 v[216:219], v80 offset:720
    ds_read_b128 v[212:215], v79 offset:2592
    v_lshlrev_b32 v42, 16, v15
    v_and_b32 v43, 0xffff0000, v15
    v_mfma_f32_32x32x16_bf16 v[144:159], v[164:167], v[180:183], v[144:159]
    ds_read_b128 v[228:231], v80 offset:3312
    ds_read_b128 v[220:223], v80 offset:752
    v_pk_mul_f32 v[42:43], v[42:43], v[72:73] op_sel:[0,0] op_sel_hi:[1,0]
    v_cvt_pk_bf16_f32 v60, v42, v43
    v_mfma_f32_32x32x16_bf16 v[128:143], v[164:167], v[172:175], v[128:143]
    v_lshlrev_b32 v42, 16, v60
    v_and_b32 v43, 0xffff0000, v60
    s_waitcnt lgkmcnt(6)
    v_mfma_f32_32x32x16_bf16 v[144:159], v[184:187], v[200:203], v[144:159]
    ds_read_b128 v[160:163], v79 offset:2432
    ds_read_b128 v[176:179], v80 offset:3120
    v_lshlrev_b32 v106, 16, v31
    v_and_b32 v107, 0xffff0000, v31
    v_mfma_f32_32x32x16_bf16 v[128:143], v[184:187], v[192:195], v[128:143]
    ds_read_b128 v[168:171], v80 offset:560
    ds_read_b128 v[164:167], v79 offset:2464
    v_lshlrev_b32 v44, 16, v16
    v_and_b32 v45, 0xffff0000, v16
    v_mfma_f32_32x32x16_bf16 v[144:159], v[188:191], v[204:207], v[144:159]
    ds_read_b128 v[180:183], v80 offset:3152
    ds_read_b128 v[172:175], v80 offset:592
    v_pk_mul_f32 v[44:45], v[44:45], v[72:73] op_sel:[0,0] op_sel_hi:[1,0]
    v_cvt_pk_bf16_f32 v60, v44, v45
    v_mfma_f32_32x32x16_bf16 v[128:143], v[188:191], v[196:199], v[128:143]
    v_lshlrev_b32 v44, 16, v60
    v_and_b32 v45, 0xffff0000, v60
    s_waitcnt lgkmcnt(6)
    v_mfma_f32_32x32x16_bf16 v[144:159], v[208:211], v[224:227], v[144:159]
    ds_read_b128 v[184:187], v79 offset:2304
    ds_read_b128 v[200:203], v80 offset:2960
    v_lshlrev_b32 v108, 16, v32
    v_and_b32 v109, 0xffff0000, v32
    v_mfma_f32_32x32x16_bf16 v[128:143], v[208:211], v[216:219], v[128:143]
    ds_read_b128 v[192:195], v80 offset:400
    ds_read_b128 v[188:191], v79 offset:2336
    v_lshlrev_b32 v46, 16, v17
    v_and_b32 v47, 0xffff0000, v17
    v_mfma_f32_32x32x16_bf16 v[144:159], v[212:215], v[228:231], v[144:159]
    ds_read_b128 v[204:207], v80 offset:2992
    ds_read_b128 v[196:199], v80 offset:432
    v_pk_mul_f32 v[46:47], v[46:47], v[72:73] op_sel:[0,0] op_sel_hi:[1,0]
    v_cvt_pk_bf16_f32 v60, v46, v47
    v_mfma_f32_32x32x16_bf16 v[128:143], v[212:215], v[220:223], v[128:143]
    v_lshlrev_b32 v46, 16, v60
    v_and_b32 v47, 0xffff0000, v60
    s_waitcnt lgkmcnt(6)
    v_mfma_f32_32x32x16_bf16 v[144:159], v[160:163], v[176:179], v[144:159]
    ds_read_b128 v[208:211], v79 offset:2176
    ds_read_b128 v[224:227], v80 offset:2800
    v_lshlrev_b32 v110, 16, v33
    v_and_b32 v111, 0xffff0000, v33
    v_mfma_f32_32x32x16_bf16 v[128:143], v[160:163], v[168:171], v[128:143]
    ds_read_b128 v[216:219], v80 offset:240
    ds_read_b128 v[212:215], v79 offset:2208
    v_lshlrev_b32 v48, 16, v18
    v_and_b32 v49, 0xffff0000, v18
    v_mfma_f32_32x32x16_bf16 v[144:159], v[164:167], v[180:183], v[144:159]
    ds_read_b128 v[228:231], v80 offset:2832
    ds_read_b128 v[220:223], v80 offset:272
    v_pk_mul_f32 v[48:49], v[48:49], v[72:73] op_sel:[0,0] op_sel_hi:[1,0]
    v_cvt_pk_bf16_f32 v60, v48, v49
    v_mfma_f32_32x32x16_bf16 v[128:143], v[164:167], v[172:175], v[128:143]
    v_lshlrev_b32 v48, 16, v60
    v_and_b32 v49, 0xffff0000, v60
    s_waitcnt lgkmcnt(6)
    v_mfma_f32_32x32x16_bf16 v[144:159], v[184:187], v[200:203], v[144:159]
    ds_read_b128 v[160:163], v79 offset:2048
    ds_read_b128 v[176:179], v80 offset:2640
    v_lshlrev_b32 v112, 16, v34
    v_and_b32 v113, 0xffff0000, v34
    v_mfma_f32_32x32x16_bf16 v[128:143], v[184:187], v[192:195], v[128:143]
    ds_read_b128 v[168:171], v80 offset:80
    ds_read_b128 v[164:167], v79 offset:2080
    v_lshlrev_b32 v50, 16, v19
    v_and_b32 v51, 0xffff0000, v19
    v_mfma_f32_32x32x16_bf16 v[144:159], v[188:191], v[204:207], v[144:159]
    ds_read_b128 v[180:183], v80 offset:2672
    ds_read_b128 v[172:175], v80 offset:112
    v_pk_mul_f32 v[50:51], v[50:51], v[72:73] op_sel:[0,0] op_sel_hi:[1,0]
    v_cvt_pk_bf16_f32 v60, v50, v51
    v_mfma_f32_32x32x16_bf16 v[128:143], v[188:191], v[196:199], v[128:143]
    v_lshlrev_b32 v50, 16, v60
    v_and_b32 v51, 0xffff0000, v60
    s_waitcnt lgkmcnt(6)
    v_mfma_f32_32x32x16_bf16 v[144:159], v[208:211], v[224:227], v[144:159]
    ds_read_b128 v[184:187], v79 offset:1920
    v_lshlrev_b32 v114, 16, v35
    v_and_b32 v115, 0xffff0000, v35
    v_mfma_f32_32x32x16_bf16 v[128:143], v[208:211], v[216:219], v[128:143]
    ds_read_b128 v[200:203], v80 offset:2480
    v_mfma_f32_32x32x16_bf16 v[144:159], v[212:215], v[228:231], v[144:159]
    ds_read_b128 v[188:191], v79 offset:1952
    v_mfma_f32_32x32x16_bf16 v[128:143], v[212:215], v[220:223], v[128:143]
    ds_read_b128 v[204:207], v80 offset:2512
    s_waitcnt lgkmcnt(4)
    v_mfma_f32_32x32x16_bf16 v[144:159], v[160:163], v[176:179], v[144:159]
    ds_read_b128 v[208:211], v79 offset:1792
    v_mfma_f32_32x32x16_bf16 v[128:143], v[160:163], v[168:171], v[128:143]
    ds_read_b128 v[224:227], v80 offset:2320
    v_mfma_f32_32x32x16_bf16 v[144:159], v[164:167], v[180:183], v[144:159]
    ds_read_b128 v[212:215], v79 offset:1824
    v_mfma_f32_32x32x16_bf16 v[128:143], v[164:167], v[172:175], v[128:143]
    ds_read_b128 v[228:231], v80 offset:2352
    s_waitcnt lgkmcnt(4)
    v_mfma_f32_32x32x16_bf16 v[144:159], v[184:187], v[200:203], v[144:159]
    ds_read_b128 v[160:163], v79 offset:1664
    ds_read_b128 v[176:179], v80 offset:2160
    v_mfma_f32_32x32x16_bf16 v[144:159], v[188:191], v[204:207], v[144:159]
    ds_read_b128 v[164:167], v79 offset:1696
    ds_read_b128 v[180:183], v80 offset:2192
    s_waitcnt lgkmcnt(4)
    v_mfma_f32_32x32x16_bf16 v[144:159], v[208:211], v[224:227], v[144:159]
    ds_read_b128 v[184:187], v79 offset:1536
    ds_read_b128 v[200:203], v80 offset:2000
    v_mfma_f32_32x32x16_bf16 v[144:159], v[212:215], v[228:231], v[144:159]
    ds_read_b128 v[188:191], v79 offset:1568
    ds_read_b128 v[204:207], v80 offset:2032
    s_waitcnt lgkmcnt(4)
    v_mfma_f32_32x32x16_bf16 v[144:159], v[160:163], v[176:179], v[144:159]
    ds_read_b128 v[208:211], v79 offset:1408
    ds_read_b128 v[224:227], v80 offset:1840
    v_mfma_f32_32x32x16_bf16 v[144:159], v[164:167], v[180:183], v[144:159]
    ds_read_b128 v[212:215], v79 offset:1440
    ds_read_b128 v[228:231], v80 offset:1872
    s_waitcnt lgkmcnt(4)
    v_mfma_f32_32x32x16_bf16 v[144:159], v[184:187], v[200:203], v[144:159]
    ds_read_b128 v[160:163], v79 offset:1280
    ds_read_b128 v[176:179], v80 offset:1680
    v_mfma_f32_32x32x16_bf16 v[144:159], v[188:191], v[204:207], v[144:159]
    ds_read_b128 v[164:167], v79 offset:1312
    ds_read_b128 v[180:183], v80 offset:1712
    s_waitcnt lgkmcnt(4)
    v_mfma_f32_32x32x16_bf16 v[144:159], v[208:211], v[224:227], v[144:159]
    ds_read_b128 v[184:187], v79 offset:1152
    ds_read_b128 v[200:203], v80 offset:1520
    v_mfma_f32_32x32x16_bf16 v[144:159], v[212:215], v[228:231], v[144:159]
    ds_read_b128 v[188:191], v79 offset:1184
    ds_read_b128 v[204:207], v80 offset:1552
    s_waitcnt lgkmcnt(4)
    v_mfma_f32_32x32x16_bf16 v[144:159], v[160:163], v[176:179], v[144:159]
    ds_read_b128 v[208:211], v79 offset:1024
    ds_read_b128 v[224:227], v80 offset:1360
    v_mfma_f32_32x32x16_bf16 v[144:159], v[164:167], v[180:183], v[144:159]
    ds_read_b128 v[212:215], v79 offset:1056
    ds_read_b128 v[228:231], v80 offset:1392
    s_waitcnt lgkmcnt(4)
    v_mfma_f32_32x32x16_bf16 v[144:159], v[184:187], v[200:203], v[144:159]
    ds_read_b128 v[160:163], v79 offset:896
    ds_read_b128 v[176:179], v80 offset:1200
    v_mfma_f32_32x32x16_bf16 v[144:159], v[188:191], v[204:207], v[144:159]
    ds_read_b128 v[164:167], v79 offset:928
    ds_read_b128 v[180:183], v80 offset:1232
    s_waitcnt lgkmcnt(4)
    v_mfma_f32_32x32x16_bf16 v[144:159], v[208:211], v[224:227], v[144:159]
    ds_read_b128 v[184:187], v79 offset:768
    ds_read_b128 v[200:203], v80 offset:1040
    v_mfma_f32_32x32x16_bf16 v[144:159], v[212:215], v[228:231], v[144:159]
    ds_read_b128 v[188:191], v79 offset:800
    ds_read_b128 v[204:207], v80 offset:1072
    s_waitcnt lgkmcnt(4)
    v_mfma_f32_32x32x16_bf16 v[144:159], v[160:163], v[176:179], v[144:159]
    ds_read_b128 v[208:211], v79 offset:640
    ds_read_b128 v[224:227], v80 offset:880
    v_mfma_f32_32x32x16_bf16 v[144:159], v[164:167], v[180:183], v[144:159]
    ds_read_b128 v[212:215], v79 offset:672
    ds_read_b128 v[228:231], v80 offset:912
    s_waitcnt lgkmcnt(4)
    v_mfma_f32_32x32x16_bf16 v[144:159], v[184:187], v[200:203], v[144:159]
    ds_read_b128 v[160:163], v79 offset:512
    ds_read_b128 v[176:179], v80 offset:720
    v_mfma_f32_32x32x16_bf16 v[144:159], v[188:191], v[204:207], v[144:159]
    ds_read_b128 v[164:167], v79 offset:544
    ds_read_b128 v[180:183], v80 offset:752
    s_waitcnt lgkmcnt(4)
    v_mfma_f32_32x32x16_bf16 v[144:159], v[208:211], v[224:227], v[144:159]
    ds_read_b128 v[184:187], v79 offset:384
    ds_read_b128 v[200:203], v80 offset:560
    v_mfma_f32_32x32x16_bf16 v[144:159], v[212:215], v[228:231], v[144:159]
    ds_read_b128 v[188:191], v79 offset:416
    ds_read_b128 v[204:207], v80 offset:592
    s_waitcnt lgkmcnt(4)
    v_mfma_f32_32x32x16_bf16 v[144:159], v[160:163], v[176:179], v[144:159]
    ds_read_b128 v[208:211], v79 offset:256
    ds_read_b128 v[224:227], v80 offset:400
    v_mfma_f32_32x32x16_bf16 v[144:159], v[164:167], v[180:183], v[144:159]
    ds_read_b128 v[212:215], v79 offset:288
    ds_read_b128 v[228:231], v80 offset:432
    s_waitcnt lgkmcnt(4)
    v_mfma_f32_32x32x16_bf16 v[144:159], v[184:187], v[200:203], v[144:159]
    ds_read_b128 v[160:163], v79 offset:128
    ds_read_b128 v[176:179], v80 offset:240
    v_mfma_f32_32x32x16_bf16 v[144:159], v[188:191], v[204:207], v[144:159]
    ds_read_b128 v[164:167], v79 offset:160
    ds_read_b128 v[180:183], v80 offset:272
    s_waitcnt lgkmcnt(4)
    v_mfma_f32_32x32x16_bf16 v[144:159], v[208:211], v[224:227], v[144:159]
    ds_read_b128 v[184:187], v79 offset:0
    ds_read_b128 v[200:203], v80 offset:80
    v_mfma_f32_32x32x16_bf16 v[144:159], v[212:215], v[228:231], v[144:159]
    ds_read_b128 v[188:191], v79 offset:32
    ds_read_b128 v[204:207], v80 offset:112
    s_waitcnt lgkmcnt(4)
    v_mfma_f32_32x32x16_bf16 v[144:159], v[160:163], v[176:179], v[144:159]
    v_mfma_f32_32x32x16_bf16 v[144:159], v[164:167], v[180:183], v[144:159]
    s_waitcnt lgkmcnt(0)
    v_mfma_f32_32x32x16_bf16 v[144:159], v[184:187], v[200:203], v[144:159]
    v_mfma_f32_32x32x16_bf16 v[144:159], v[188:191], v[204:207], v[144:159]
    v_readfirstlane_b32 s30, v77
    s_nop 7
    s_nop 7
    s_cmp_eq_u32 s30, 0
    s_cbranch_scc0 conv_par1
    ds_write_b128 v84, v[144:147] offset:0
    ds_write_b128 v84, v[148:151] offset:1024
    ds_write_b128 v84, v[152:155] offset:2048
    ds_write_b128 v84, v[156:159] offset:3072
    s_branch conv_parj
conv_par1:
    ds_write_b128 v84, v[128:131] offset:0
    ds_write_b128 v84, v[132:135] offset:1024
    ds_write_b128 v84, v[136:139] offset:2048
    ds_write_b128 v84, v[140:143] offset:3072
    s_waitcnt lgkmcnt(0)
    v_pk_mov_b32 v[128:129], v[144:145], v[144:145] op_sel:[0,1]
    v_pk_mov_b32 v[130:131], v[146:147], v[146:147] op_sel:[0,1]
    v_pk_mov_b32 v[132:133], v[148:149], v[148:149] op_sel:[0,1]
    v_pk_mov_b32 v[134:135], v[150:151], v[150:151] op_sel:[0,1]
    v_pk_mov_b32 v[136:137], v[152:153], v[152:153] op_sel:[0,1]
    v_pk_mov_b32 v[138:139], v[154:155], v[154:155] op_sel:[0,1]
    v_pk_mov_b32 v[140:141], v[156:157], v[156:157] op_sel:[0,1]
    v_pk_mov_b32 v[142:143], v[158:159], v[158:159] op_sel:[0,1]
conv_parj:
    s_waitcnt lgkmcnt(0)
    s_barrier
    ds_read_b128 v[20:23], v83 offset:0
    ds_read_b128 v[24:27], v83 offset:1024
    ds_read_b128 v[28:31], v83 offset:2048
    ds_read_b128 v[32:35], v83 offset:3072
    s_waitcnt lgkmcnt(3)
    v_pk_add_f32 v[128:129], v[128:129], v[20:21]
    v_cvt_pk_bf16_f32 v60, v128, v129
    v_lshlrev_b32 v62, 16, v60
    v_and_b32 v63, 0xffff0000, v60
    v_pk_add_f32 v[62:63], v[36:37], v[62:63]
    v_cvt_pk_bf16_f32 v60, v62, v63
    v_lshlrev_b32 v62, 16, v60
    v_and_b32 v63, 0xffff0000, v60
    v_pk_add_f32 v[62:63], v[62:63], v[100:101]
    v_cvt_pk_bf16_f32 v52, v62, v63
    v_pk_add_f32 v[130:131], v[130:131], v[22:23]
    v_cvt_pk_bf16_f32 v64, v130, v131
    v_lshlrev_b32 v66, 16, v64
    v_and_b32 v67, 0xffff0000, v64
    v_pk_add_f32 v[66:67], v[38:39], v[66:67]
    v_cvt_pk_bf16_f32 v64, v66, v67
    v_lshlrev_b32 v66, 16, v64
    v_and_b32 v67, 0xffff0000, v64
    v_pk_add_f32 v[66:67], v[66:67], v[102:103]
    v_cvt_pk_bf16_f32 v53, v66, v67
    buffer_store_dwordx2 v[52:53], v86, s[8:11], s14 offen offset:0
    s_waitcnt lgkmcnt(2)
    v_pk_add_f32 v[132:133], v[132:133], v[24:25]
    v_cvt_pk_bf16_f32 v60, v132, v133
    v_lshlrev_b32 v62, 16, v60
    v_and_b32 v63, 0xffff0000, v60
    v_pk_add_f32 v[62:63], v[40:41], v[62:63]
    v_cvt_pk_bf16_f32 v60, v62, v63
    v_lshlrev_b32 v62, 16, v60
    v_and_b32 v63, 0xffff0000, v60
    v_pk_add_f32 v[62:63], v[62:63], v[104:105]
    v_cvt_pk_bf16_f32 v54, v62, v63
    v_pk_add_f32 v[134:135], v[134:135], v[26:27]
    v_cvt_pk_bf16_f32 v64, v134, v135
    v_lshlrev_b32 v66, 16, v64
    v_and_b32 v67, 0xffff0000, v64
    v_pk_add_f32 v[66:67], v[42:43], v[66:67]
    v_cvt_pk_bf16_f32 v64, v66, v67
    v_lshlrev_b32 v66, 16, v64
    v_and_b32 v67, 0xffff0000, v64
    v_pk_add_f32 v[66:67], v[66:67], v[106:107]
    v_cvt_pk_bf16_f32 v55, v66, v67
    buffer_store_dwordx2 v[54:55], v86, s[8:11], s14 offen offset:16
    s_waitcnt lgkmcnt(1)
    v_pk_add_f32 v[136:137], v[136:137], v[28:29]
    v_cvt_pk_bf16_f32 v60, v136, v137
    v_lshlrev_b32 v62, 16, v60
    v_and_b32 v63, 0xffff0000, v60
    v_pk_add_f32 v[62:63], v[44:45], v[62:63]
    v_cvt_pk_bf16_f32 v60, v62, v63
    v_lshlrev_b32 v62, 16, v60
    v_and_b32 v63, 0xffff0000, v60
    v_pk_add_f32 v[62:63], v[62:63], v[108:109]
    v_cvt_pk_bf16_f32 v56, v62, v63
    v_pk_add_f32 v[138:139], v[138:139], v[30:31]
    v_cvt_pk_bf16_f32 v64, v138, v139
    v_lshlrev_b32 v66, 16, v64
    v_and_b32 v67, 0xffff0000, v64
    v_pk_add_f32 v[66:67], v[46:47], v[66:67]
    v_cvt_pk_bf16_f32 v64, v66, v67
    v_lshlrev_b32 v66, 16, v64
    v_and_b32 v67, 0xffff0000, v64
    v_pk_add_f32 v[66:67], v[66:67], v[110:111]
    v_cvt_pk_bf16_f32 v57, v66, v67
    buffer_store_dwordx2 v[56:57], v86, s[8:11], s14 offen offset:32
    s_waitcnt lgkmcnt(0)
    v_pk_add_f32 v[140:141], v[140:141], v[32:33]
    v_cvt_pk_bf16_f32 v60, v140, v141
    v_lshlrev_b32 v62, 16, v60
    v_and_b32 v63, 0xffff0000, v60
    v_pk_add_f32 v[62:63], v[48:49], v[62:63]
    v_cvt_pk_bf16_f32 v60, v62, v63
    v_lshlrev_b32 v62, 16, v60
    v_and_b32 v63, 0xffff0000, v60
    v_pk_add_f32 v[62:63], v[62:63], v[112:113]
    v_cvt_pk_bf16_f32 v58, v62, v63
    v_pk_add_f32 v[142:143], v[142:143], v[34:35]
    v_cvt_pk_bf16_f32 v64, v142, v143
    v_lshlrev_b32 v66, 16, v64
    v_and_b32 v67, 0xffff0000, v64
    v_pk_add_f32 v[66:67], v[50:51], v[66:67]
    v_cvt_pk_bf16_f32 v64, v66, v67
    v_lshlrev_b32 v66, 16, v64
    v_and_b32 v67, 0xffff0000, v64
    v_pk_add_f32 v[66:67], v[66:67], v[114:115]
    v_cvt_pk_bf16_f32 v59, v66, v67
    buffer_store_dwordx2 v[58:59], v86, s[8:11], s14 offen offset:48
conv1_kernel_end:
    s_endpgm
.globl qkv2_kernel
.p2align 8
.type qkv2_kernel,@function
qkv2_kernel:
    s_load_dwordx2 s[4:5], s[0:1], 112
    s_load_dwordx2 s[6:7], s[0:1], 96
    s_cmp_ge_u32 s2, 256
    s_cbranch_scc1 qkv1_kernel_end
    s_mov_b32 s40, 6291456
    s_branch qkv1_kernel_body
.globl qkv1_kernel
.p2align 8
.type qkv1_kernel,@function
qkv1_kernel:
    s_load_dwordx2 s[4:5], s[0:1], 112
    s_load_dwordx2 s[6:7], s[0:1], 96
    s_cmp_ge_u32 s2, 256
    s_cbranch_scc1 qkv1_kernel_end
    s_mov_b32 s40, 2097152
qkv1_kernel_body:
    s_and_b32 s12, s2, 1
    s_lshl_b32 s12, s12, 2
    s_bfe_u32 s13, s2, 0x20003
    s_add_u32 s12, s12, s13
    s_bfe_u32 s13, s2, 0x20001
    s_lshl_b32 s13, s13, 3
    s_lshr_b32 s14, s2, 5
    s_add_u32 s13, s13, s14
    s_lshl_b32 s14, s13, 7
    s_add_u32 s14, s14, s40
    v_and_b32 v1, 7, v0
    v_lshrrev_b32 v2, 3, v0
    v_lshlrev_b32 v3, 12, v2
    v_lshl_add_u32 v3, v1, 4, v3
    s_mov_b32 s15, s14
    s_lshl_b32 s16, s12, 8
    s_add_u32 s16, s16, 25296896
    s_add_u32 s17, s16, 4096
    v_and_b32 v4, 0xf0, v0
    v_and_b32 v5, 15, v0
    v_lshrrev_b32 v6, 6, v0
    v_lshlrev_b32 v6, 6, v6
    v_lshl_add_u32 v6, v5, 2, v6
    s_mov_b32 s10, 0x10000000
    s_mov_b32 s11, 0x00020000
    s_waitcnt lgkmcnt(0)
    s_mov_b32 s8, s4
    s_and_b32 s9, s5, 0xffff
    buffer_load_dwordx4 v[160:163], v4, s[8:11], s16 offen
    buffer_load_dwordx4 v[164:167], v4, s[8:11], s16 offen offset:2048
    buffer_load_dword v168, v6, s[8:11], s17 offen
    buffer_load_dwordx4 v[16:19], v3, s[8:11], s15 offen
    s_add_u32 s15, s15, 0x20000
    buffer_load_dwordx4 v[20:23], v3, s[8:11], s15 offen
    s_add_u32 s15, s15, 0x20000
    buffer_load_dwordx4 v[24:27], v3, s[8:11], s15 offen
    s_add_u32 s15, s15, 0x20000
    buffer_load_dwordx4 v[28:31], v3, s[8:11], s15 offen
    s_add_u32 s15, s15, 0x20000
    buffer_load_dwordx4 v[32:35], v3, s[8:11], s15 offen
    s_add_u32 s15, s15, 0x20000
    buffer_load_dwordx4 v[36:39], v3, s[8:11], s15 offen
    s_add_u32 s15, s15, 0x20000
    buffer_load_dwordx4 v[40:43], v3, s[8:11], s15 offen
    s_add_u32 s15, s15, 0x20000
    buffer_load_dwordx4 v[44:47], v3, s[8:11], s15 offen
    s_add_u32 s15, s15, 0x20000
    v_lshrrev_b32 v4, 6, v0
    v_mul_u32_u24 v6, 49152, v4
    v_and_b32 v5, 63, v0
    v_lshl_add_u32 v6, v5, 4, v6
    s_mul_i32 s17, s12, 196608
    s_add_u32 s17, s17, 13631488
    s_add_u32 s18, s17, 16384
    s_add_u32 s19, s17, 32768
    buffer_load_dwordx4 a[0:3], v6, s[8:11], s17 offen offset:0
    buffer_load_dwordx4 a[4:7], v6, s[8:11], s18 offen offset:0
    buffer_load_dwordx4 a[8:11], v6, s[8:11], s19 offen offset:0
    buffer_load_dwordx4 a[12:15], v6, s[8:11], s17 offen offset:1024
    buffer_load_dwordx4 a[16:19], v6, s[8:11], s18 offen offset:1024
    buffer_load_dwordx4 a[20:23], v6, s[8:11], s19 offen offset:1024
    v_and_b32 v5, 15, v0
    v_bfe_u32 v7, v0, 4, 2
    v_mul_u32_u24 v11, 160, v2
    v_lshl_add_u32 v11, v1, 4, v11
    v_add_u32 v12, 40960, v11
    v_lshrrev_b32 v13, 2, v5
    v_lshl_add_u32 v13, v7, 2, v13
    v_mul_u32_u24 v13, 160, v13
    v_and_b32 v14, 3, v0
    v_lshl_add_u32 v13, v14, 3, v13
    v_add_u32 v14, 40960, v13
    v_lshl_add_u32 v8, v4, 5, v13
    v_add_u32 v9, 40960, v8
    v_mov_b32 v180, 0x3f803f80
    v_mov_b32 v181, 0x3f803f80
    v_mov_b32 v182, 0x3f803f80
    v_mov_b32 v183, 0x3f803f80
    s_lshl_b32 s16, s12, 2
    v_add_u32 v4, s16, v4
    s_waitcnt vmcnt(13)
    ds_write_b128 v11, v[16:19] offset:0
    s_waitcnt vmcnt(12)
    ds_write_b128 v11, v[20:23] offset:5120
    s_waitcnt vmcnt(11)
    ds_write_b128 v11, v[24:27] offset:10240
    s_waitcnt vmcnt(10)
    ds_write_b128 v11, v[28:31] offset:15360
    s_waitcnt vmcnt(9)
    ds_write_b128 v11, v[32:35] offset:20480
    s_waitcnt vmcnt(8)
    ds_write_b128 v11, v[36:39] offset:25600
    s_waitcnt vmcnt(7)
    ds_write_b128 v11, v[40:43] offset:30720
    s_waitcnt vmcnt(6)
    ds_write_b128 v11, v[44:47] offset:35840
    s_lshl_b32 s22, s13, 11
    s_add_u32 s23, s22, 18874368
    s_add_u32 s24, s22, 20971520
    s_add_u32 s22, s22, 16777216
    v_lshlrev_b32 v15, 16, v4
    v_lshl_add_u32 v15, v5, 4, v15
    v_lshrrev_b32 v82, 1, v7
    v_and_b32 v83, 1, v7
    v_lshl_add_u32 v10, v83, 8, v15
    v_lshl_add_u32 v10, v82, 3, v10
    v_lshl_add_u32 v15, v82, 9, v15
    v_lshl_add_u32 v15, v83, 3, v15
    s_waitcnt lgkmcnt(0)
    s_barrier
    ds_read_b64_tr_b16 v[192:193], v13 offset:0
    ds_read_b64_tr_b16 v[194:195], v13 offset:2560
    ds_read_b64_tr_b16 v[196:197], v13 offset:32
    ds_read_b64_tr_b16 v[198:199], v13 offset:2592
    ds_read_b64_tr_b16 v[200:201], v13 offset:64
    ds_read_b64_tr_b16 v[202:203], v13 offset:2624
    ds_read_b64_tr_b16 v[204:205], v13 offset:96
    ds_read_b64_tr_b16 v[206:207], v13 offset:2656
    ds_read_b64_tr_b16 v[208:209], v8 offset:0
    ds_read_b64_tr_b16 v[210:211], v8 offset:2560
    s_waitcnt vmcnt(3) lgkmcnt(8)
    v_mfma_f32_16x16x32_bf16 v[112:115], a[0:3], v[192:195], 0
    ds_read_b64_tr_b16 v[212:213], v13 offset:5120
    v_mfma_f32_16x16x32_bf16 v[128:131], a[4:7], v[192:195], 0
    ds_read_b64_tr_b16 v[214:215], v13 offset:7680
    v_mfma_f32_16x16x32_bf16 v[144:147], v[192:195], a[8:11], 0
    ds_read_b64_tr_b16 v[216:217], v13 offset:5152
    s_waitcnt lgkmcnt(9)
    v_mfma_f32_16x16x32_bf16 v[116:119], a[0:3], v[196:199], 0
    ds_read_b64_tr_b16 v[218:219], v13 offset:7712
    buffer_load_dwordx4 a[24:27], v6, s[8:11], s17 offen offset:2048
    v_mfma_f32_16x16x32_bf16 v[132:135], a[4:7], v[196:199], 0
    ds_read_b64_tr_b16 v[220:221], v13 offset:5184
    buffer_load_dwordx4 a[28:31], v6, s[8:11], s18 offen offset:2048
    v_mfma_f32_16x16x32_bf16 v[148:151], v[196:199], a[8:11], 0
    ds_read_b64_tr_b16 v[222:223], v13 offset:7744
    buffer_load_dwordx4 a[32:35], v6, s[8:11], s19 offen offset:2048
    s_waitcnt lgkmcnt(10)
    v_mfma_f32_16x16x32_bf16 v[120:123], a[0:3], v[200:203], 0
    ds_read_b64_tr_b16 v[224:225], v13 offset:5216
    buffer_load_dwordx4 v[48:51], v3, s[8:11], s15 offen
    s_add_u32 s15, s15, 0x20000
    v_mfma_f32_16x16x32_bf16 v[136:139], a[4:7], v[200:203], 0
    ds_read_b64_tr_b16 v[226:227], v13 offset:7776
    buffer_load_dwordx4 v[52:55], v3, s[8:11], s15 offen
    s_add_u32 s15, s15, 0x20000
    v_mfma_f32_16x16x32_bf16 v[152:155], v[200:203], a[8:11], 0
    ds_read_b64_tr_b16 v[228:229], v8 offset:5120
    buffer_load_dwordx4 v[56:59], v3, s[8:11], s15 offen
    s_add_u32 s15, s15, 0x20000
    s_waitcnt lgkmcnt(11)
    v_mfma_f32_16x16x32_bf16 v[124:127], a[0:3], v[204:207], 0
    ds_read_b64_tr_b16 v[230:231], v8 offset:7680
    buffer_load_dwordx4 v[60:63], v3, s[8:11], s15 offen
    s_add_u32 s15, s15, 0x20000
    v_mfma_f32_16x16x32_bf16 v[140:143], a[4:7], v[204:207], 0
    v_mfma_f32_16x16x32_bf16 v[156:159], v[204:207], a[8:11], 0
    s_waitcnt lgkmcnt(10)
    v_mfma_f32_16x16x32_bf16 v[172:175], v[208:211], v[208:211], 0
    v_mfma_f32_16x16x32_bf16 v[176:179], v[180:183], v[208:211], 0
    s_waitcnt vmcnt(7) lgkmcnt(8)
    v_mfma_f32_16x16x32_bf16 v[112:115], a[12:15], v[212:215], v[112:115]
    ds_read_b64_tr_b16 v[192:193], v13 offset:10240
    v_mfma_f32_16x16x32_bf16 v[128:131], a[16:19], v[212:215], v[128:131]
    ds_read_b64_tr_b16 v[194:195], v13 offset:12800
    v_mfma_f32_16x16x32_bf16 v[144:147], v[212:215], a[20:23], v[144:147]
    ds_read_b64_tr_b16 v[196:197], v13 offset:10272
    s_waitcnt lgkmcnt(9)
    v_mfma_f32_16x16x32_bf16 v[116:119], a[12:15], v[216:219], v[116:119]
    ds_read_b64_tr_b16 v[198:199], v13 offset:12832
    buffer_load_dwordx4 a[36:39], v6, s[8:11], s17 offen offset:3072
    s_add_u32 s17, s17, 4096
    v_mfma_f32_16x16x32_bf16 v[132:135], a[16:19], v[216:219], v[132:135]
    ds_read_b64_tr_b16 v[200:201], v13 offset:10304
    buffer_load_dwordx4 a[40:43], v6, s[8:11], s18 offen offset:3072
    s_add_u32 s18, s18, 4096
    v_mfma_f32_16x16x32_bf16 v[148:151], v[216:219], a[20:23], v[148:151]
    ds_read_b64_tr_b16 v[202:203], v13 offset:12864
    buffer_load_dwordx4 a[44:47], v6, s[8:11], s19 offen offset:3072
    s_add_u32 s19, s19, 4096
    s_waitcnt lgkmcnt(10)
    v_mfma_f32_16x16x32_bf16 v[120:123], a[12:15], v[220:223], v[120:123]
    ds_read_b64_tr_b16 v[204:205], v13 offset:10336
    buffer_load_dwordx4 v[64:67], v3, s[8:11], s15 offen
    s_add_u32 s15, s15, 0x20000
    v_mfma_f32_16x16x32_bf16 v[136:139], a[16:19], v[220:223], v[136:139]
    ds_read_b64_tr_b16 v[206:207], v13 offset:12896
    buffer_load_dwordx4 v[68:71], v3, s[8:11], s15 offen
    s_add_u32 s15, s15, 0x20000
    v_mfma_f32_16x16x32_bf16 v[152:155], v[220:223], a[20:23], v[152:155]
    ds_read_b64_tr_b16 v[208:209], v8 offset:10240
    buffer_load_dwordx4 v[72:75], v3, s[8:11], s15 offen
    s_add_u32 s15, s15, 0x20000
    s_waitcnt lgkmcnt(11)
    v_mfma_f32_16x16x32_bf16 v[124:127], a[12:15], v[224:227], v[124:127]
    ds_read_b64_tr_b16 v[210:211], v8 offset:12800
    buffer_load_dwordx4 v[76:79], v3, s[8:11], s15 offen
    v_mfma_f32_16x16x32_bf16 v[140:143], a[16:19], v[224:227], v[140:143]
    v_mfma_f32_16x16x32_bf16 v[156:159], v[224:227], a[20:23], v[156:159]
    s_waitcnt lgkmcnt(10)
    v_mfma_f32_16x16x32_bf16 v[172:175], v[228:231], v[228:231], v[172:175]
    v_mfma_f32_16x16x32_bf16 v[176:179], v[180:183], v[228:231], v[176:179]
    s_waitcnt vmcnt(11) lgkmcnt(8)
    v_mfma_f32_16x16x32_bf16 v[112:115], a[24:27], v[192:195], v[112:115]
    ds_read_b64_tr_b16 v[212:213], v13 offset:15360
    v_mfma_f32_16x16x32_bf16 v[128:131], a[28:31], v[192:195], v[128:131]
    ds_read_b64_tr_b16 v[214:215], v13 offset:17920
    v_mfma_f32_16x16x32_bf16 v[144:147], v[192:195], a[32:35], v[144:147]
    ds_read_b64_tr_b16 v[216:217], v13 offset:15392
    s_waitcnt lgkmcnt(9)
    v_mfma_f32_16x16x32_bf16 v[116:119], a[24:27], v[196:199], v[116:119]
    ds_read_b64_tr_b16 v[218:219], v13 offset:17952
    buffer_load_dwordx4 a[48:51], v6, s[8:11], s17 offen offset:0
    v_mfma_f32_16x16x32_bf16 v[132:135], a[28:31], v[196:199], v[132:135]
    ds_read_b64_tr_b16 v[220:221], v13 offset:15424
    buffer_load_dwordx4 a[52:55], v6, s[8:11], s18 offen offset:0
    v_mfma_f32_16x16x32_bf16 v[148:151], v[196:199], a[32:35], v[148:151]
    ds_read_b64_tr_b16 v[222:223], v13 offset:17984
    buffer_load_dwordx4 a[56:59], v6, s[8:11], s19 offen offset:0
    s_waitcnt lgkmcnt(10)
    v_mfma_f32_16x16x32_bf16 v[120:123], a[24:27], v[200:203], v[120:123]
    ds_read_b64_tr_b16 v[224:225], v13 offset:15456
    buffer_load_dwordx4 a[60:63], v6, s[8:11], s17 offen offset:1024
    v_mfma_f32_16x16x32_bf16 v[136:139], a[28:31], v[200:203], v[136:139]
    ds_read_b64_tr_b16 v[226:227], v13 offset:18016
    buffer_load_dwordx4 a[64:67], v6, s[8:11], s18 offen offset:1024
    v_mfma_f32_16x16x32_bf16 v[152:155], v[200:203], a[32:35], v[152:155]
    ds_read_b64_tr_b16 v[228:229], v8 offset:15360
    buffer_load_dwordx4 a[68:71], v6, s[8:11], s19 offen offset:1024
    s_waitcnt lgkmcnt(11)
    v_mfma_f32_16x16x32_bf16 v[124:127], a[24:27], v[204:207], v[124:127]
    ds_read_b64_tr_b16 v[230:231], v8 offset:17920
    v_mfma_f32_16x16x32_bf16 v[140:143], a[28:31], v[204:207], v[140:143]
    v_mfma_f32_16x16x32_bf16 v[156:159], v[204:207], a[32:35], v[156:159]
    s_waitcnt lgkmcnt(10)
    v_mfma_f32_16x16x32_bf16 v[172:175], v[208:211], v[208:211], v[172:175]
    v_mfma_f32_16x16x32_bf16 v[176:179], v[180:183], v[208:211], v[176:179]
    s_waitcnt vmcnt(10) lgkmcnt(8)
    v_mfma_f32_16x16x32_bf16 v[112:115], a[36:39], v[212:215], v[112:115]
    ds_read_b64_tr_b16 v[192:193], v13 offset:20480
    v_mfma_f32_16x16x32_bf16 v[128:131], a[40:43], v[212:215], v[128:131]
    ds_read_b64_tr_b16 v[194:195], v13 offset:23040
    v_mfma_f32_16x16x32_bf16 v[144:147], v[212:215], a[44:47], v[144:147]
    ds_read_b64_tr_b16 v[196:197], v13 offset:20512
    s_waitcnt lgkmcnt(9)
    v_mfma_f32_16x16x32_bf16 v[116:119], a[36:39], v[216:219], v[116:119]
    ds_read_b64_tr_b16 v[198:199], v13 offset:23072
    buffer_load_dwordx4 a[72:75], v6, s[8:11], s17 offen offset:2048
    v_mfma_f32_16x16x32_bf16 v[132:135], a[40:43], v[216:219], v[132:135]
    ds_read_b64_tr_b16 v[200:201], v13 offset:20544
    buffer_load_dwordx4 a[76:79], v6, s[8:11], s18 offen offset:2048
    v_mfma_f32_16x16x32_bf16 v[148:151], v[216:219], a[44:47], v[148:151]
    ds_read_b64_tr_b16 v[202:203], v13 offset:23104
    buffer_load_dwordx4 a[80:83], v6, s[8:11], s19 offen offset:2048
    s_waitcnt lgkmcnt(10)
    v_mfma_f32_16x16x32_bf16 v[120:123], a[36:39], v[220:223], v[120:123]
    ds_read_b64_tr_b16 v[204:205], v13 offset:20576
    buffer_load_dwordx4 a[84:87], v6, s[8:11], s17 offen offset:3072
    s_add_u32 s17, s17, 4096
    v_mfma_f32_16x16x32_bf16 v[136:139], a[40:43], v[220:223], v[136:139]
    ds_read_b64_tr_b16 v[206:207], v13 offset:23136
    buffer_load_dwordx4 a[88:91], v6, s[8:11], s18 offen offset:3072
    s_add_u32 s18, s18, 4096
    v_mfma_f32_16x16x32_bf16 v[152:155], v[220:223], a[44:47], v[152:155]
    ds_read_b64_tr_b16 v[208:209], v8 offset:20480
    buffer_load_dwordx4 a[92:95], v6, s[8:11], s19 offen offset:3072
    s_add_u32 s19, s19, 4096
    s_waitcnt lgkmcnt(11)
    v_mfma_f32_16x16x32_bf16 v[124:127], a[36:39], v[224:227], v[124:127]
    ds_read_b64_tr_b16 v[210:211], v8 offset:23040
    v_mfma_f32_16x16x32_bf16 v[140:143], a[40:43], v[224:227], v[140:143]
    v_mfma_f32_16x16x32_bf16 v[156:159], v[224:227], a[44:47], v[156:159]
    s_waitcnt lgkmcnt(10)
    v_mfma_f32_16x16x32_bf16 v[172:175], v[228:231], v[228:231], v[172:175]
    v_mfma_f32_16x16x32_bf16 v[176:179], v[180:183], v[228:231], v[176:179]
    s_waitcnt vmcnt(9) lgkmcnt(8)
    v_mfma_f32_16x16x32_bf16 v[112:115], a[48:51], v[192:195], v[112:115]
    ds_read_b64_tr_b16 v[212:213], v13 offset:25600
    v_mfma_f32_16x16x32_bf16 v[128:131], a[52:55], v[192:195], v[128:131]
    ds_read_b64_tr_b16 v[214:215], v13 offset:28160
    v_mfma_f32_16x16x32_bf16 v[144:147], v[192:195], a[56:59], v[144:147]
    ds_read_b64_tr_b16 v[216:217], v13 offset:25632
    s_waitcnt lgkmcnt(9)
    v_mfma_f32_16x16x32_bf16 v[116:119], a[48:51], v[196:199], v[116:119]
    ds_read_b64_tr_b16 v[218:219], v13 offset:28192
    buffer_load_dwordx4 a[96:99], v6, s[8:11], s17 offen offset:0
    v_mfma_f32_16x16x32_bf16 v[132:135], a[52:55], v[196:199], v[132:135]
    ds_read_b64_tr_b16 v[220:221], v13 offset:25664
    buffer_load_dwordx4 a[100:103], v6, s[8:11], s18 offen offset:0
    v_mfma_f32_16x16x32_bf16 v[148:151], v[196:199], a[56:59], v[148:151]
    ds_read_b64_tr_b16 v[222:223], v13 offset:28224
    buffer_load_dwordx4 a[104:107], v6, s[8:11], s19 offen offset:0
    s_waitcnt lgkmcnt(10)
    v_mfma_f32_16x16x32_bf16 v[120:123], a[48:51], v[200:203], v[120:123]
    ds_read_b64_tr_b16 v[224:225], v13 offset:25696
    v_mfma_f32_16x16x32_bf16 v[136:139], a[52:55], v[200:203], v[136:139]
    ds_read_b64_tr_b16 v[226:227], v13 offset:28256
    v_mfma_f32_16x16x32_bf16 v[152:155], v[200:203], a[56:59], v[152:155]
    ds_read_b64_tr_b16 v[228:229], v8 offset:25600
    s_waitcnt lgkmcnt(11)
    v_mfma_f32_16x16x32_bf16 v[124:127], a[48:51], v[204:207], v[124:127]
    ds_read_b64_tr_b16 v[230:231], v8 offset:28160
    v_mfma_f32_16x16x32_bf16 v[140:143], a[52:55], v[204:207], v[140:143]
    v_mfma_f32_16x16x32_bf16 v[156:159], v[204:207], a[56:59], v[156:159]
    s_waitcnt lgkmcnt(10)
    v_mfma_f32_16x16x32_bf16 v[172:175], v[208:211], v[208:211], v[172:175]
    v_mfma_f32_16x16x32_bf16 v[176:179], v[180:183], v[208:211], v[176:179]
    s_waitcnt vmcnt(9) lgkmcnt(8)
    v_mfma_f32_16x16x32_bf16 v[112:115], a[60:63], v[212:215], v[112:115]
    ds_write_b128 v12, v[48:51] offset:0
    ds_write_b128 v12, v[52:55] offset:5120
    ds_write_b128 v12, v[56:59] offset:10240
    ds_write_b128 v12, v[60:63] offset:15360
    ds_write_b128 v12, v[64:67] offset:20480
    ds_write_b128 v12, v[68:71] offset:25600
    ds_write_b128 v12, v[72:75] offset:30720
    ds_write_b128 v12, v[76:79] offset:35840
    ds_read_b64_tr_b16 v[192:193], v13 offset:30720
    v_mfma_f32_16x16x32_bf16 v[128:131], a[64:67], v[212:215], v[128:131]
    ds_read_b64_tr_b16 v[194:195], v13 offset:33280
    v_mfma_f32_16x16x32_bf16 v[144:147], v[212:215], a[68:71], v[144:147]
    ds_read_b64_tr_b16 v[196:197], v13 offset:30752
    s_waitcnt lgkmcnt(15)
    v_mfma_f32_16x16x32_bf16 v[116:119], a[60:63], v[216:219], v[116:119]
    ds_read_b64_tr_b16 v[198:199], v13 offset:33312
    buffer_load_dwordx4 a[108:111], v6, s[8:11], s17 offen offset:1024
    v_mfma_f32_16x16x32_bf16 v[132:135], a[64:67], v[216:219], v[132:135]
    ds_read_b64_tr_b16 v[200:201], v13 offset:30784
    buffer_load_dwordx4 a[112:115], v6, s[8:11], s18 offen offset:1024
    v_mfma_f32_16x16x32_bf16 v[148:151], v[216:219], a[68:71], v[148:151]
    ds_read_b64_tr_b16 v[202:203], v13 offset:33344
    buffer_load_dwordx4 a[116:119], v6, s[8:11], s19 offen offset:1024
    s_waitcnt lgkmcnt(15)
    v_mfma_f32_16x16x32_bf16 v[120:123], a[60:63], v[220:223], v[120:123]
    ds_read_b64_tr_b16 v[204:205], v13 offset:30816
    v_mfma_f32_16x16x32_bf16 v[136:139], a[64:67], v[220:223], v[136:139]
    ds_read_b64_tr_b16 v[206:207], v13 offset:33376
    v_mfma_f32_16x16x32_bf16 v[152:155], v[220:223], a[68:71], v[152:155]
    ds_read_b64_tr_b16 v[208:209], v8 offset:30720
    s_waitcnt lgkmcnt(15)
    v_mfma_f32_16x16x32_bf16 v[124:127], a[60:63], v[224:227], v[124:127]
    ds_read_b64_tr_b16 v[210:211], v8 offset:33280
    v_mfma_f32_16x16x32_bf16 v[140:143], a[64:67], v[224:227], v[140:143]
    v_mfma_f32_16x16x32_bf16 v[156:159], v[224:227], a[68:71], v[156:159]
    s_waitcnt lgkmcnt(15)
    v_mfma_f32_16x16x32_bf16 v[172:175], v[228:231], v[228:231], v[172:175]
    v_mfma_f32_16x16x32_bf16 v[176:179], v[180:183], v[228:231], v[176:179]
    s_waitcnt vmcnt(9) lgkmcnt(8)
    v_mfma_f32_16x16x32_bf16 v[112:115], a[72:75], v[192:195], v[112:115]
    ds_read_b64_tr_b16 v[212:213], v13 offset:35840
    v_mfma_f32_16x16x32_bf16 v[128:131], a[76:79], v[192:195], v[128:131]
    ds_read_b64_tr_b16 v[214:215], v13 offset:38400
    v_mfma_f32_16x16x32_bf16 v[144:147], v[192:195], a[80:83], v[144:147]
    ds_read_b64_tr_b16 v[216:217], v13 offset:35872
    s_waitcnt lgkmcnt(9)
    v_mfma_f32_16x16x32_bf16 v[116:119], a[72:75], v[196:199], v[116:119]
    ds_read_b64_tr_b16 v[218:219], v13 offset:38432
    buffer_load_dwordx4 a[120:123], v6, s[8:11], s17 offen offset:2048
    v_mfma_f32_16x16x32_bf16 v[132:135], a[76:79], v[196:199], v[132:135]
    ds_read_b64_tr_b16 v[220:221], v13 offset:35904
    buffer_load_dwordx4 a[124:127], v6, s[8:11], s18 offen offset:2048
    v_mfma_f32_16x16x32_bf16 v[148:151], v[196:199], a[80:83], v[148:151]
    ds_read_b64_tr_b16 v[222:223], v13 offset:38464
    buffer_load_dwordx4 a[128:131], v6, s[8:11], s19 offen offset:2048
    s_waitcnt lgkmcnt(10)
    v_mfma_f32_16x16x32_bf16 v[120:123], a[72:75], v[200:203], v[120:123]
    ds_read_b64_tr_b16 v[224:225], v13 offset:35936
    v_mfma_f32_16x16x32_bf16 v[136:139], a[76:79], v[200:203], v[136:139]
    ds_read_b64_tr_b16 v[226:227], v13 offset:38496
    v_mfma_f32_16x16x32_bf16 v[152:155], v[200:203], a[80:83], v[152:155]
    ds_read_b64_tr_b16 v[228:229], v8 offset:35840
    s_waitcnt lgkmcnt(11)
    v_mfma_f32_16x16x32_bf16 v[124:127], a[72:75], v[204:207], v[124:127]
    ds_read_b64_tr_b16 v[230:231], v8 offset:38400
    v_mfma_f32_16x16x32_bf16 v[140:143], a[76:79], v[204:207], v[140:143]
    v_mfma_f32_16x16x32_bf16 v[156:159], v[204:207], a[80:83], v[156:159]
    s_waitcnt lgkmcnt(10)
    v_mfma_f32_16x16x32_bf16 v[172:175], v[208:211], v[208:211], v[172:175]
    v_mfma_f32_16x16x32_bf16 v[176:179], v[180:183], v[208:211], v[176:179]
    s_waitcnt lgkmcnt(0)
    s_barrier
    s_waitcnt vmcnt(9) lgkmcnt(8)
    v_mfma_f32_16x16x32_bf16 v[112:115], a[84:87], v[212:215], v[112:115]
    ds_read_b64_tr_b16 v[192:193], v14 offset:0
    v_mfma_f32_16x16x32_bf16 v[128:131], a[88:91], v[212:215], v[128:131]
    ds_read_b64_tr_b16 v[194:195], v14 offset:2560
    v_mfma_f32_16x16x32_bf16 v[144:147], v[212:215], a[92:95], v[144:147]
    ds_read_b64_tr_b16 v[196:197], v14 offset:32
    s_waitcnt lgkmcnt(9)
    v_mfma_f32_16x16x32_bf16 v[116:119], a[84:87], v[216:219], v[116:119]
    ds_read_b64_tr_b16 v[198:199], v14 offset:2592
    buffer_load_dwordx4 a[132:135], v6, s[8:11], s17 offen offset:3072
    s_add_u32 s17, s17, 4096
    v_mfma_f32_16x16x32_bf16 v[132:135], a[88:91], v[216:219], v[132:135]
    ds_read_b64_tr_b16 v[200:201], v14 offset:64
    buffer_load_dwordx4 a[136:139], v6, s[8:11], s18 offen offset:3072
    s_add_u32 s18, s18, 4096
    v_mfma_f32_16x16x32_bf16 v[148:151], v[216:219], a[92:95], v[148:151]
    ds_read_b64_tr_b16 v[202:203], v14 offset:2624
    buffer_load_dwordx4 a[140:143], v6, s[8:11], s19 offen offset:3072
    s_add_u32 s19, s19, 4096
    s_waitcnt lgkmcnt(10)
    v_mfma_f32_16x16x32_bf16 v[120:123], a[84:87], v[220:223], v[120:123]
    ds_read_b64_tr_b16 v[204:205], v14 offset:96
    v_mfma_f32_16x16x32_bf16 v[136:139], a[88:91], v[220:223], v[136:139]
    ds_read_b64_tr_b16 v[206:207], v14 offset:2656
    v_mfma_f32_16x16x32_bf16 v[152:155], v[220:223], a[92:95], v[152:155]
    ds_read_b64_tr_b16 v[208:209], v9 offset:0
    s_waitcnt lgkmcnt(11)
    v_mfma_f32_16x16x32_bf16 v[124:127], a[84:87], v[224:227], v[124:127]
    ds_read_b64_tr_b16 v[210:211], v9 offset:2560
    v_mfma_f32_16x16x32_bf16 v[140:143], a[88:91], v[224:227], v[140:143]
    v_mfma_f32_16x16x32_bf16 v[156:159], v[224:227], a[92:95], v[156:159]
    s_waitcnt lgkmcnt(10)
    v_mfma_f32_16x16x32_bf16 v[172:175], v[228:231], v[228:231], v[172:175]
    v_mfma_f32_16x16x32_bf16 v[176:179], v[180:183], v[228:231], v[176:179]
    s_waitcnt vmcnt(9) lgkmcnt(8)
    v_mfma_f32_16x16x32_bf16 v[112:115], a[96:99], v[192:195], v[112:115]
    ds_read_b64_tr_b16 v[212:213], v14 offset:5120
    v_mfma_f32_16x16x32_bf16 v[128:131], a[100:103], v[192:195], v[128:131]
    ds_read_b64_tr_b16 v[214:215], v14 offset:7680
    v_mfma_f32_16x16x32_bf16 v[144:147], v[192:195], a[104:107], v[144:147]
    ds_read_b64_tr_b16 v[216:217], v14 offset:5152
    s_waitcnt lgkmcnt(9)
    v_mfma_f32_16x16x32_bf16 v[116:119], a[96:99], v[196:199], v[116:119]
    ds_read_b64_tr_b16 v[218:219], v14 offset:7712
    buffer_load_dwordx4 a[144:147], v6, s[8:11], s17 offen offset:0
    v_mfma_f32_16x16x32_bf16 v[132:135], a[100:103], v[196:199], v[132:135]
    ds_read_b64_tr_b16 v[220:221], v14 offset:5184
    buffer_load_dwordx4 a[148:151], v6, s[8:11], s18 offen offset:0
    v_mfma_f32_16x16x32_bf16 v[148:151], v[196:199], a[104:107], v[148:151]
    ds_read_b64_tr_b16 v[222:223], v14 offset:7744
    buffer_load_dwordx4 a[152:155], v6, s[8:11], s19 offen offset:0
    s_waitcnt lgkmcnt(10)
    v_mfma_f32_16x16x32_bf16 v[120:123], a[96:99], v[200:203], v[120:123]
    ds_read_b64_tr_b16 v[224:225], v14 offset:5216
    v_mfma_f32_16x16x32_bf16 v[136:139], a[100:103], v[200:203], v[136:139]
    ds_read_b64_tr_b16 v[226:227], v14 offset:7776
    v_mfma_f32_16x16x32_bf16 v[152:155], v[200:203], a[104:107], v[152:155]
    ds_read_b64_tr_b16 v[228:229], v9 offset:5120
    s_waitcnt lgkmcnt(11)
    v_mfma_f32_16x16x32_bf16 v[124:127], a[96:99], v[204:207], v[124:127]
    ds_read_b64_tr_b16 v[230:231], v9 offset:7680
    v_mfma_f32_16x16x32_bf16 v[140:143], a[100:103], v[204:207], v[140:143]
    v_mfma_f32_16x16x32_bf16 v[156:159], v[204:207], a[104:107], v[156:159]
    s_waitcnt lgkmcnt(10)
    v_mfma_f32_16x16x32_bf16 v[172:175], v[208:211], v[208:211], v[172:175]
    v_mfma_f32_16x16x32_bf16 v[176:179], v[180:183], v[208:211], v[176:179]
    s_waitcnt vmcnt(9) lgkmcnt(8)
    v_mfma_f32_16x16x32_bf16 v[112:115], a[108:111], v[212:215], v[112:115]
    ds_read_b64_tr_b16 v[192:193], v14 offset:10240
    v_mfma_f32_16x16x32_bf16 v[128:131], a[112:115], v[212:215], v[128:131]
    ds_read_b64_tr_b16 v[194:195], v14 offset:12800
    v_mfma_f32_16x16x32_bf16 v[144:147], v[212:215], a[116:119], v[144:147]
    ds_read_b64_tr_b16 v[196:197], v14 offset:10272
    s_waitcnt lgkmcnt(9)
    v_mfma_f32_16x16x32_bf16 v[116:119], a[108:111], v[216:219], v[116:119]
    ds_read_b64_tr_b16 v[198:199], v14 offset:12832
    buffer_load_dwordx4 a[156:159], v6, s[8:11], s17 offen offset:1024
    v_mfma_f32_16x16x32_bf16 v[132:135], a[112:115], v[216:219], v[132:135]
    ds_read_b64_tr_b16 v[200:201], v14 offset:10304
    buffer_load_dwordx4 a[160:163], v6, s[8:11], s18 offen offset:1024
    v_mfma_f32_16x16x32_bf16 v[148:151], v[216:219], a[116:119], v[148:151]
    ds_read_b64_tr_b16 v[202:203], v14 offset:12864
    buffer_load_dwordx4 a[164:167], v6, s[8:11], s19 offen offset:1024
    s_waitcnt lgkmcnt(10)
    v_mfma_f32_16x16x32_bf16 v[120:123], a[108:111], v[220:223], v[120:123]
    ds_read_b64_tr_b16 v[204:205], v14 offset:10336
    v_mfma_f32_16x16x32_bf16 v[136:139], a[112:115], v[220:223], v[136:139]
    ds_read_b64_tr_b16 v[206:207], v14 offset:12896
    v_mfma_f32_16x16x32_bf16 v[152:155], v[220:223], a[116:119], v[152:155]
    ds_read_b64_tr_b16 v[208:209], v9 offset:10240
    s_waitcnt lgkmcnt(11)
    v_mfma_f32_16x16x32_bf16 v[124:127], a[108:111], v[224:227], v[124:127]
    ds_read_b64_tr_b16 v[210:211], v9 offset:12800
    v_mfma_f32_16x16x32_bf16 v[140:143], a[112:115], v[224:227], v[140:143]
    v_mfma_f32_16x16x32_bf16 v[156:159], v[224:227], a[116:119], v[156:159]
    s_waitcnt lgkmcnt(10)
    v_mfma_f32_16x16x32_bf16 v[172:175], v[228:231], v[228:231], v[172:175]
    v_mfma_f32_16x16x32_bf16 v[176:179], v[180:183], v[228:231], v[176:179]
    s_waitcnt vmcnt(9) lgkmcnt(8)
    v_mfma_f32_16x16x32_bf16 v[112:115], a[120:123], v[192:195], v[112:115]
    ds_read_b64_tr_b16 v[212:213], v14 offset:15360
    v_mfma_f32_16x16x32_bf16 v[128:131], a[124:127], v[192:195], v[128:131]
    ds_read_b64_tr_b16 v[214:215], v14 offset:17920
    v_mfma_f32_16x16x32_bf16 v[144:147], v[192:195], a[128:131], v[144:147]
    ds_read_b64_tr_b16 v[216:217], v14 offset:15392
    s_waitcnt lgkmcnt(9)
    v_mfma_f32_16x16x32_bf16 v[116:119], a[120:123], v[196:199], v[116:119]
    ds_read_b64_tr_b16 v[218:219], v14 offset:17952
    buffer_load_dwordx4 a[168:171], v6, s[8:11], s17 offen offset:2048
    v_mfma_f32_16x16x32_bf16 v[132:135], a[124:127], v[196:199], v[132:135]
    ds_read_b64_tr_b16 v[220:221], v14 offset:15424
    buffer_load_dwordx4 a[172:175], v6, s[8:11], s18 offen offset:2048
    v_mfma_f32_16x16x32_bf16 v[148:151], v[196:199], a[128:131], v[148:151]
    ds_read_b64_tr_b16 v[222:223], v14 offset:17984
    buffer_load_dwordx4 a[176:179], v6, s[8:11], s19 offen offset:2048
    s_waitcnt lgkmcnt(10)
    v_mfma_f32_16x16x32_bf16 v[120:123], a[120:123], v[200:203], v[120:123]
    ds_read_b64_tr_b16 v[224:225], v14 offset:15456
    v_mfma_f32_16x16x32_bf16 v[136:139], a[124:127], v[200:203], v[136:139]
    ds_read_b64_tr_b16 v[226:227], v14 offset:18016
    v_mfma_f32_16x16x32_bf16 v[152:155], v[200:203], a[128:131], v[152:155]
    ds_read_b64_tr_b16 v[228:229], v9 offset:15360
    s_waitcnt lgkmcnt(11)
    v_mfma_f32_16x16x32_bf16 v[124:127], a[120:123], v[204:207], v[124:127]
    ds_read_b64_tr_b16 v[230:231], v9 offset:17920
    v_mfma_f32_16x16x32_bf16 v[140:143], a[124:127], v[204:207], v[140:143]
    v_mfma_f32_16x16x32_bf16 v[156:159], v[204:207], a[128:131], v[156:159]
    s_waitcnt lgkmcnt(10)
    v_mfma_f32_16x16x32_bf16 v[172:175], v[208:211], v[208:211], v[172:175]
    v_mfma_f32_16x16x32_bf16 v[176:179], v[180:183], v[208:211], v[176:179]
    s_waitcnt vmcnt(9) lgkmcnt(8)
    v_mfma_f32_16x16x32_bf16 v[112:115], a[132:135], v[212:215], v[112:115]
    ds_read_b64_tr_b16 v[192:193], v14 offset:20480
    v_mfma_f32_16x16x32_bf16 v[128:131], a[136:139], v[212:215], v[128:131]
    ds_read_b64_tr_b16 v[194:195], v14 offset:23040
    v_mfma_f32_16x16x32_bf16 v[144:147], v[212:215], a[140:143], v[144:147]
    ds_read_b64_tr_b16 v[196:197], v14 offset:20512
    s_waitcnt lgkmcnt(9)
    v_mfma_f32_16x16x32_bf16 v[116:119], a[132:135], v[216:219], v[116:119]
    ds_read_b64_tr_b16 v[198:199], v14 offset:23072
    buffer_load_dwordx4 a[180:183], v6, s[8:11], s17 offen offset:3072
    v_mfma_f32_16x16x32_bf16 v[132:135], a[136:139], v[216:219], v[132:135]
    ds_read_b64_tr_b16 v[200:201], v14 offset:20544
    buffer_load_dwordx4 a[184:187], v6, s[8:11], s18 offen offset:3072
    v_mfma_f32_16x16x32_bf16 v[148:151], v[216:219], a[140:143], v[148:151]
    ds_read_b64_tr_b16 v[202:203], v14 offset:23104
    buffer_load_dwordx4 a[188:191], v6, s[8:11], s19 offen offset:3072
    s_waitcnt lgkmcnt(10)
    v_mfma_f32_16x16x32_bf16 v[120:123], a[132:135], v[220:223], v[120:123]
    ds_read_b64_tr_b16 v[204:205], v14 offset:20576
    v_mfma_f32_16x16x32_bf16 v[136:139], a[136:139], v[220:223], v[136:139]
    ds_read_b64_tr_b16 v[206:207], v14 offset:23136
    v_mfma_f32_16x16x32_bf16 v[152:155], v[220:223], a[140:143], v[152:155]
    ds_read_b64_tr_b16 v[208:209], v9 offset:20480
    s_waitcnt lgkmcnt(11)
    v_mfma_f32_16x16x32_bf16 v[124:127], a[132:135], v[224:227], v[124:127]
    ds_read_b64_tr_b16 v[210:211], v9 offset:23040
    v_mfma_f32_16x16x32_bf16 v[140:143], a[136:139], v[224:227], v[140:143]
    v_mfma_f32_16x16x32_bf16 v[156:159], v[224:227], a[140:143], v[156:159]
    s_waitcnt lgkmcnt(10)
    v_mfma_f32_16x16x32_bf16 v[172:175], v[228:231], v[228:231], v[172:175]
    v_mfma_f32_16x16x32_bf16 v[176:179], v[180:183], v[228:231], v[176:179]
    s_waitcnt vmcnt(9) lgkmcnt(8)
    v_mfma_f32_16x16x32_bf16 v[112:115], a[144:147], v[192:195], v[112:115]
    ds_read_b64_tr_b16 v[212:213], v14 offset:25600
    v_mfma_f32_16x16x32_bf16 v[128:131], a[148:151], v[192:195], v[128:131]
    ds_read_b64_tr_b16 v[214:215], v14 offset:28160
    v_mfma_f32_16x16x32_bf16 v[144:147], v[192:195], a[152:155], v[144:147]
    ds_read_b64_tr_b16 v[216:217], v14 offset:25632
    s_waitcnt lgkmcnt(9)
    v_mfma_f32_16x16x32_bf16 v[116:119], a[144:147], v[196:199], v[116:119]
    ds_read_b64_tr_b16 v[218:219], v14 offset:28192
    v_mfma_f32_16x16x32_bf16 v[132:135], a[148:151], v[196:199], v[132:135]
    ds_read_b64_tr_b16 v[220:221], v14 offset:25664
    v_mfma_f32_16x16x32_bf16 v[148:151], v[196:199], a[152:155], v[148:151]
    ds_read_b64_tr_b16 v[222:223], v14 offset:28224
    s_waitcnt lgkmcnt(10)
    v_mfma_f32_16x16x32_bf16 v[120:123], a[144:147], v[200:203], v[120:123]
    ds_read_b64_tr_b16 v[224:225], v14 offset:25696
    v_mfma_f32_16x16x32_bf16 v[136:139], a[148:151], v[200:203], v[136:139]
    ds_read_b64_tr_b16 v[226:227], v14 offset:28256
    v_mfma_f32_16x16x32_bf16 v[152:155], v[200:203], a[152:155], v[152:155]
    ds_read_b64_tr_b16 v[228:229], v9 offset:25600
    s_waitcnt lgkmcnt(11)
    v_mfma_f32_16x16x32_bf16 v[124:127], a[144:147], v[204:207], v[124:127]
    ds_read_b64_tr_b16 v[230:231], v9 offset:28160
    v_mfma_f32_16x16x32_bf16 v[140:143], a[148:151], v[204:207], v[140:143]
    v_mfma_f32_16x16x32_bf16 v[156:159], v[204:207], a[152:155], v[156:159]
    s_waitcnt lgkmcnt(10)
    v_mfma_f32_16x16x32_bf16 v[172:175], v[208:211], v[208:211], v[172:175]
    v_mfma_f32_16x16x32_bf16 v[176:179], v[180:183], v[208:211], v[176:179]
    s_waitcnt vmcnt(6) lgkmcnt(8)
    v_mfma_f32_16x16x32_bf16 v[112:115], a[156:159], v[212:215], v[112:115]
    ds_read_b64_tr_b16 v[192:193], v14 offset:30720
    v_mfma_f32_16x16x32_bf16 v[128:131], a[160:163], v[212:215], v[128:131]
    ds_read_b64_tr_b16 v[194:195], v14 offset:33280
    v_mfma_f32_16x16x32_bf16 v[144:147], v[212:215], a[164:167], v[144:147]
    ds_read_b64_tr_b16 v[196:197], v14 offset:30752
    s_waitcnt lgkmcnt(9)
    v_mfma_f32_16x16x32_bf16 v[116:119], a[156:159], v[216:219], v[116:119]
    ds_read_b64_tr_b16 v[198:199], v14 offset:33312
    v_mfma_f32_16x16x32_bf16 v[132:135], a[160:163], v[216:219], v[132:135]
    ds_read_b64_tr_b16 v[200:201], v14 offset:30784
    v_mfma_f32_16x16x32_bf16 v[148:151], v[216:219], a[164:167], v[148:151]
    ds_read_b64_tr_b16 v[202:203], v14 offset:33344
    s_waitcnt lgkmcnt(10)
    v_mfma_f32_16x16x32_bf16 v[120:123], a[156:159], v[220:223], v[120:123]
    ds_read_b64_tr_b16 v[204:205], v14 offset:30816
    v_mfma_f32_16x16x32_bf16 v[136:139], a[160:163], v[220:223], v[136:139]
    ds_read_b64_tr_b16 v[206:207], v14 offset:33376
    v_mfma_f32_16x16x32_bf16 v[152:155], v[220:223], a[164:167], v[152:155]
    ds_read_b64_tr_b16 v[208:209], v9 offset:30720
    s_waitcnt lgkmcnt(11)
    v_mfma_f32_16x16x32_bf16 v[124:127], a[156:159], v[224:227], v[124:127]
    ds_read_b64_tr_b16 v[210:211], v9 offset:33280
    v_mfma_f32_16x16x32_bf16 v[140:143], a[160:163], v[224:227], v[140:143]
    v_mfma_f32_16x16x32_bf16 v[156:159], v[224:227], a[164:167], v[156:159]
    s_waitcnt lgkmcnt(10)
    v_mfma_f32_16x16x32_bf16 v[172:175], v[228:231], v[228:231], v[172:175]
    v_mfma_f32_16x16x32_bf16 v[176:179], v[180:183], v[228:231], v[176:179]
    s_waitcnt vmcnt(3) lgkmcnt(8)
    v_mfma_f32_16x16x32_bf16 v[112:115], a[168:171], v[192:195], v[112:115]
    ds_read_b64_tr_b16 v[212:213], v14 offset:35840
    v_mfma_f32_16x16x32_bf16 v[128:131], a[172:175], v[192:195], v[128:131]
    ds_read_b64_tr_b16 v[214:215], v14 offset:38400
    v_mfma_f32_16x16x32_bf16 v[144:147], v[192:195], a[176:179], v[144:147]
    ds_read_b64_tr_b16 v[216:217], v14 offset:35872
    s_waitcnt lgkmcnt(9)
    v_mfma_f32_16x16x32_bf16 v[116:119], a[168:171], v[196:199], v[116:119]
    ds_read_b64_tr_b16 v[218:219], v14 offset:38432
    v_mfma_f32_16x16x32_bf16 v[132:135], a[172:175], v[196:199], v[132:135]
    ds_read_b64_tr_b16 v[220:221], v14 offset:35904
    v_mfma_f32_16x16x32_bf16 v[148:151], v[196:199], a[176:179], v[148:151]
    ds_read_b64_tr_b16 v[222:223], v14 offset:38464
    s_waitcnt lgkmcnt(10)
    v_mfma_f32_16x16x32_bf16 v[120:123], a[168:171], v[200:203], v[120:123]
    ds_read_b64_tr_b16 v[224:225], v14 offset:35936
    v_mfma_f32_16x16x32_bf16 v[136:139], a[172:175], v[200:203], v[136:139]
    ds_read_b64_tr_b16 v[226:227], v14 offset:38496
    v_mfma_f32_16x16x32_bf16 v[152:155], v[200:203], a[176:179], v[152:155]
    ds_read_b64_tr_b16 v[228:229], v9 offset:35840
    s_waitcnt lgkmcnt(11)
    v_mfma_f32_16x16x32_bf16 v[124:127], a[168:171], v[204:207], v[124:127]
    ds_read_b64_tr_b16 v[230:231], v9 offset:38400
    v_mfma_f32_16x16x32_bf16 v[140:143], a[172:175], v[204:207], v[140:143]
    v_mfma_f32_16x16x32_bf16 v[156:159], v[204:207], a[176:179], v[156:159]
    s_waitcnt lgkmcnt(10)
    v_mfma_f32_16x16x32_bf16 v[172:175], v[208:211], v[208:211], v[172:175]
    v_mfma_f32_16x16x32_bf16 v[176:179], v[180:183], v[208:211], v[176:179]
    s_waitcnt vmcnt(0) lgkmcnt(8)
    v_mfma_f32_16x16x32_bf16 v[112:115], a[180:183], v[212:215], v[112:115]
    v_mfma_f32_16x16x32_bf16 v[128:131], a[184:187], v[212:215], v[128:131]
    v_mfma_f32_16x16x32_bf16 v[144:147], v[212:215], a[188:191], v[144:147]
    s_waitcnt lgkmcnt(6)
    v_mfma_f32_16x16x32_bf16 v[116:119], a[180:183], v[216:219], v[116:119]
    v_mfma_f32_16x16x32_bf16 v[132:135], a[184:187], v[216:219], v[132:135]
    v_mfma_f32_16x16x32_bf16 v[148:151], v[216:219], a[188:191], v[148:151]
    s_waitcnt lgkmcnt(4)
    v_mfma_f32_16x16x32_bf16 v[120:123], a[180:183], v[220:223], v[120:123]
    v_mfma_f32_16x16x32_bf16 v[136:139], a[184:187], v[220:223], v[136:139]
    v_mfma_f32_16x16x32_bf16 v[152:155], v[220:223], a[188:191], v[152:155]
    s_waitcnt lgkmcnt(2)
    v_mfma_f32_16x16x32_bf16 v[124:127], a[180:183], v[224:227], v[124:127]
    v_mfma_f32_16x16x32_bf16 v[140:143], a[184:187], v[224:227], v[140:143]
    v_mfma_f32_16x16x32_bf16 v[156:159], v[224:227], a[188:191], v[156:159]
    s_waitcnt lgkmcnt(0)
    v_mfma_f32_16x16x32_bf16 v[172:175], v[228:231], v[228:231], v[172:175]
    v_mfma_f32_16x16x32_bf16 v[176:179], v[180:183], v[228:231], v[176:179]
    s_nop 4
    v_lshlrev_b32 v56, 2, v7
    v_sub_u32 v56, v5, v56
    v_cmp_eq_u32 vcc, 1, v56
    v_cmp_eq_u32 s[26:27], 2, v56
    v_cmp_eq_u32 s[28:29], 3, v56
    v_lshrrev_b32 v57, 6, v0
    v_lshl_add_u32 v57, v57, 4, v5
    v_lshlrev_b32 v57, 2, v57
    v_add_u32 v57, 81920, v57
    v_cndmask_b32 v172, v172, v173, vcc
    v_cndmask_b32 v172, v172, v174, s[26:27]
    v_cndmask_b32 v172, v172, v175, s[28:29]
    v_mul_f32 v176, 0x3b000000, v176
    v_mul_f32 v172, 0x3b000000, v172
    v_fma_f32 v172, -v176, v176, v172
    v_max_f32 v172, 0, v172
    v_cvt_pk_bf16_f32 v58, v176, v172
    v_lshlrev_b32 v176, 16, v58
    v_and_b32 v172, 0xffff0000, v58
    v_add_f32 v172, 0x3727c5ac, v172
    v_cvt_pk_bf16_f32 v58, v172, v172
    v_lshlrev_b32 v172, 16, v58
    v_sqrt_f32 v172, v172
    s_nop 0
    v_cvt_pk_bf16_f32 v58, v172, v172
    v_lshlrev_b32 v172, 16, v58
    v_rcp_f32 v172, v172
    s_nop 0
    v_mul_f32 v176, v176, v172
    v_cmp_gt_u32 vcc, 4, v56
    s_and_saveexec_b64 s[20:21], vcc
    ds_write2_b32 v57, v172, v176 offset0:0 offset1:64
    s_mov_b64 exec, s[20:21]
    v_lshlrev_b32 v58, 2, v5
    v_add_u32 v58, 81920, v58
    v_lshlrev_b32 v59, 4, v7
    v_add_u32 v59, 81920, v59
    s_waitcnt lgkmcnt(0)
    s_barrier
    ds_read2_b32 v[16:17], v58 offset0:0 offset1:64
    ds_read2_b32 v[18:19], v58 offset0:16 offset1:80
    ds_read2_b32 v[20:21], v58 offset0:32 offset1:96
    ds_read2_b32 v[22:23], v58 offset0:48 offset1:112
    ds_read_b128 v[24:27], v59 offset:0
    ds_read_b128 v[28:31], v59 offset:256
    ds_read_b128 v[32:35], v59 offset:64
    ds_read_b128 v[36:39], v59 offset:320
    ds_read_b128 v[40:43], v59 offset:128
    ds_read_b128 v[44:47], v59 offset:384
    ds_read_b128 v[48:51], v59 offset:192
    ds_read_b128 v[52:55], v59 offset:448
    s_waitcnt lgkmcnt(8)
    v_pk_mul_f32 v[60:61], v[160:161], v[16:17] op_sel:[0,1] op_sel_hi:[1,1]
    v_pk_fma_f32 v[112:113], v[112:113], v[16:17], v[60:61] op_sel:[0,0,0] op_sel_hi:[1,0,1] neg_lo:[0,0,1] neg_hi:[0,0,1]
    v_pk_mul_f32 v[60:61], v[162:163], v[16:17] op_sel:[0,1] op_sel_hi:[1,1]
    v_pk_fma_f32 v[114:115], v[114:115], v[16:17], v[60:61] op_sel:[0,0,0] op_sel_hi:[1,0,1] neg_lo:[0,0,1] neg_hi:[0,0,1]
    v_cvt_pk_bf16_f32 v112, v112, v113
    v_cvt_pk_bf16_f32 v113, v114, v115
    buffer_store_dwordx2 v[112:113], v15, s[8:11], s22 offen offset:0
    v_pk_mul_f32 v[60:61], v[160:161], v[18:19] op_sel:[0,1] op_sel_hi:[1,1]
    v_pk_fma_f32 v[116:117], v[116:117], v[18:19], v[60:61] op_sel:[0,0,0] op_sel_hi:[1,0,1] neg_lo:[0,0,1] neg_hi:[0,0,1]
    v_pk_mul_f32 v[60:61], v[162:163], v[18:19] op_sel:[0,1] op_sel_hi:[1,1]
    v_pk_fma_f32 v[118:119], v[118:119], v[18:19], v[60:61] op_sel:[0,0,0] op_sel_hi:[1,0,1] neg_lo:[0,0,1] neg_hi:[0,0,1]
    v_cvt_pk_bf16_f32 v116, v116, v117
    v_cvt_pk_bf16_f32 v117, v118, v119
    buffer_store_dwordx2 v[116:117], v15, s[8:11], s22 offen offset:256
    v_pk_mul_f32 v[60:61], v[160:161], v[20:21] op_sel:[0,1] op_sel_hi:[1,1]
    v_pk_fma_f32 v[120:121], v[120:121], v[20:21], v[60:61] op_sel:[0,0,0] op_sel_hi:[1,0,1] neg_lo:[0,0,1] neg_hi:[0,0,1]
    v_pk_mul_f32 v[60:61], v[162:163], v[20:21] op_sel:[0,1] op_sel_hi:[1,1]
    v_pk_fma_f32 v[122:123], v[122:123], v[20:21], v[60:61] op_sel:[0,0,0] op_sel_hi:[1,0,1] neg_lo:[0,0,1] neg_hi:[0,0,1]
    v_cvt_pk_bf16_f32 v120, v120, v121
    v_cvt_pk_bf16_f32 v121, v122, v123
    buffer_store_dwordx2 v[120:121], v15, s[8:11], s22 offen offset:1024
    v_pk_mul_f32 v[60:61], v[160:161], v[22:23] op_sel:[0,1] op_sel_hi:[1,1]
    v_pk_fma_f32 v[124:125], v[124:125], v[22:23], v[60:61] op_sel:[0,0,0] op_sel_hi:[1,0,1] neg_lo:[0,0,1] neg_hi:[0,0,1]
    v_pk_mul_f32 v[60:61], v[162:163], v[22:23] op_sel:[0,1] op_sel_hi:[1,1]
    v_pk_fma_f32 v[126:127], v[126:127], v[22:23], v[60:61] op_sel:[0,0,0] op_sel_hi:[1,0,1] neg_lo:[0,0,1] neg_hi:[0,0,1]
    v_cvt_pk_bf16_f32 v124, v124, v125
    v_cvt_pk_bf16_f32 v125, v126, v127
    buffer_store_dwordx2 v[124:125], v15, s[8:11], s22 offen offset:1280
    v_pk_mul_f32 v[60:61], v[164:165], v[16:17] op_sel:[0,1] op_sel_hi:[1,1]
    v_pk_fma_f32 v[128:129], v[128:129], v[16:17], v[60:61] op_sel:[0,0,0] op_sel_hi:[1,0,1] neg_lo:[0,0,1] neg_hi:[0,0,1]
    v_pk_mul_f32 v[60:61], v[166:167], v[16:17] op_sel:[0,1] op_sel_hi:[1,1]
    v_pk_fma_f32 v[130:131], v[130:131], v[16:17], v[60:61] op_sel:[0,0,0] op_sel_hi:[1,0,1] neg_lo:[0,0,1] neg_hi:[0,0,1]
    v_cvt_pk_bf16_f32 v128, v128, v129
    v_cvt_pk_bf16_f32 v129, v130, v131
    buffer_store_dwordx2 v[128:129], v15, s[8:11], s23 offen offset:0
    v_pk_mul_f32 v[60:61], v[164:165], v[18:19] op_sel:[0,1] op_sel_hi:[1,1]
    v_pk_fma_f32 v[132:133], v[132:133], v[18:19], v[60:61] op_sel:[0,0,0] op_sel_hi:[1,0,1] neg_lo:[0,0,1] neg_hi:[0,0,1]
    v_pk_mul_f32 v[60:61], v[166:167], v[18:19] op_sel:[0,1] op_sel_hi:[1,1]
    v_pk_fma_f32 v[134:135], v[134:135], v[18:19], v[60:61] op_sel:[0,0,0] op_sel_hi:[1,0,1] neg_lo:[0,0,1] neg_hi:[0,0,1]
    v_cvt_pk_bf16_f32 v132, v132, v133
    v_cvt_pk_bf16_f32 v133, v134, v135
    buffer_store_dwordx2 v[132:133], v15, s[8:11], s23 offen offset:256
    v_pk_mul_f32 v[60:61], v[164:165], v[20:21] op_sel:[0,1] op_sel_hi:[1,1]
    v_pk_fma_f32 v[136:137], v[136:137], v[20:21], v[60:61] op_sel:[0,0,0] op_sel_hi:[1,0,1] neg_lo:[0,0,1] neg_hi:[0,0,1]
    v_pk_mul_f32 v[60:61], v[166:167], v[20:21] op_sel:[0,1] op_sel_hi:[1,1]
    v_pk_fma_f32 v[138:139], v[138:139], v[20:21], v[60:61] op_sel:[0,0,0] op_sel_hi:[1,0,1] neg_lo:[0,0,1] neg_hi:[0,0,1]
    v_cvt_pk_bf16_f32 v136, v136, v137
    v_cvt_pk_bf16_f32 v137, v138, v139
    buffer_store_dwordx2 v[136:137], v15, s[8:11], s23 offen offset:1024
    v_pk_mul_f32 v[60:61], v[164:165], v[22:23] op_sel:[0,1] op_sel_hi:[1,1]
    v_pk_fma_f32 v[140:141], v[140:141], v[22:23], v[60:61] op_sel:[0,0,0] op_sel_hi:[1,0,1] neg_lo:[0,0,1] neg_hi:[0,0,1]
    v_pk_mul_f32 v[60:61], v[166:167], v[22:23] op_sel:[0,1] op_sel_hi:[1,1]
    v_pk_fma_f32 v[142:143], v[142:143], v[22:23], v[60:61] op_sel:[0,0,0] op_sel_hi:[1,0,1] neg_lo:[0,0,1] neg_hi:[0,0,1]
    v_cvt_pk_bf16_f32 v140, v140, v141
    v_cvt_pk_bf16_f32 v141, v142, v143
    buffer_store_dwordx2 v[140:141], v15, s[8:11], s23 offen offset:1280
    s_waitcnt lgkmcnt(0)
    v_pk_mul_f32 v[60:61], v[28:29], v[168:169] op_sel:[0,0] op_sel_hi:[1,0]
    v_pk_fma_f32 v[144:145], v[144:145], v[24:25], v[60:61] neg_lo:[0,0,1] neg_hi:[0,0,1]
    v_pk_mul_f32 v[60:61], v[30:31], v[168:169] op_sel:[0,0] op_sel_hi:[1,0]
    v_pk_fma_f32 v[146:147], v[146:147], v[26:27], v[60:61] neg_lo:[0,0,1] neg_hi:[0,0,1]
    v_cvt_pk_bf16_f32 v144, v144, v145
    v_cvt_pk_bf16_f32 v145, v146, v147
    buffer_store_dwordx2 v[144:145], v10, s[8:11], s24 offen offset:0
    v_pk_mul_f32 v[60:61], v[36:37], v[168:169] op_sel:[0,0] op_sel_hi:[1,0]
    v_pk_fma_f32 v[148:149], v[148:149], v[32:33], v[60:61] neg_lo:[0,0,1] neg_hi:[0,0,1]
    v_pk_mul_f32 v[60:61], v[38:39], v[168:169] op_sel:[0,0] op_sel_hi:[1,0]
    v_pk_fma_f32 v[150:151], v[150:151], v[34:35], v[60:61] neg_lo:[0,0,1] neg_hi:[0,0,1]
    v_cvt_pk_bf16_f32 v148, v148, v149
    v_cvt_pk_bf16_f32 v149, v150, v151
    buffer_store_dwordx2 v[148:149], v10, s[8:11], s24 offen offset:512
    v_pk_mul_f32 v[60:61], v[44:45], v[168:169] op_sel:[0,0] op_sel_hi:[1,0]
    v_pk_fma_f32 v[152:153], v[152:153], v[40:41], v[60:61] neg_lo:[0,0,1] neg_hi:[0,0,1]
    v_pk_mul_f32 v[60:61], v[46:47], v[168:169] op_sel:[0,0] op_sel_hi:[1,0]
    v_pk_fma_f32 v[154:155], v[154:155], v[42:43], v[60:61] neg_lo:[0,0,1] neg_hi:[0,0,1]
    v_cvt_pk_bf16_f32 v152, v152, v153
    v_cvt_pk_bf16_f32 v153, v154, v155
    buffer_store_dwordx2 v[152:153], v10, s[8:11], s24 offen offset:1024
    v_pk_mul_f32 v[60:61], v[52:53], v[168:169] op_sel:[0,0] op_sel_hi:[1,0]
    v_pk_fma_f32 v[156:157], v[156:157], v[48:49], v[60:61] neg_lo:[0,0,1] neg_hi:[0,0,1]
    v_pk_mul_f32 v[60:61], v[54:55], v[168:169] op_sel:[0,0] op_sel_hi:[1,0]
    v_pk_fma_f32 v[158:159], v[158:159], v[50:51], v[60:61] neg_lo:[0,0,1] neg_hi:[0,0,1]
    v_cvt_pk_bf16_f32 v156, v156, v157
    v_cvt_pk_bf16_f32 v157, v158, v159
    buffer_store_dwordx2 v[156:157], v10, s[8:11], s24 offen offset:1536
qkv1_kernel_end:
    s_endpgm
.globl attn1_kernel
.p2align 8
.type attn1_kernel,@function
attn1_kernel:
    s_load_dwordx2 s[4:5], s[0:1], 112
    s_load_dwordx2 s[6:7], s[0:1], 96
    s_cmp_ge_u32 s2, 512
    s_cbranch_scc1 attn1_kernel_end
    s_and_b32 s13, s2, 1
    s_lshl_b32 s13, s13, 2
    s_bfe_u32 s12, s2, 0x20003
    s_add_u32 s13, s13, s12
    s_bfe_u32 s12, s2, 0x20001
    s_lshl_b32 s12, s12, 4
    s_lshr_b32 s14, s2, 5
    s_add_u32 s12, s12, s14
    v_lshrrev_b32 v1, 6, v0
    s_lshl_b32 s14, s13, 2
    v_add_u32 v1, s14, v1
    v_and_b32 v2, 31, v0
    v_bfe_u32 v3, v0, 5, 1
    v_and_b32 v4, 63, v0
    v_lshlrev_b32 v4, 4, v4
    v_lshl_add_u32 v4, v1, 16, v4
    s_lshl_b32 s15, s12, 10
    s_add_u32 s16, s15, 16777216
    s_mov_b32 s10, 0x10000000
    s_mov_b32 s11, 0x00020000
    s_waitcnt lgkmcnt(0)
    s_mov_b32 s8, s4
    s_and_b32 s9, s5, 0xffff
    buffer_load_dwordx4 v[8:11], v4, s[8:11], s16 offen
    s_add_u32 s17, s15, 18866176
    buffer_load_dwordx4 v[12:15], v4, s[8:11], s17 offen offset:0
    buffer_load_dwordx4 v[16:19], v4, s[8:11], s17 offen offset:1024
    buffer_load_dwordx4 v[20:23], v4, s[8:11], s17 offen offset:2048
    buffer_load_dwordx4 v[24:27], v4, s[8:11], s17 offen offset:3072
    s_add_u32 s17, s17, 4096
    buffer_load_dwordx4 v[28:31], v4, s[8:11], s17 offen offset:0
    buffer_load_dwordx4 v[32:35], v4, s[8:11], s17 offen offset:1024
    buffer_load_dwordx4 v[36:39], v4, s[8:11], s17 offen offset:2048
    buffer_load_dwordx4 v[40:43], v4, s[8:11], s17 offen offset:3072
    s_add_u32 s17, s17, 4096
    buffer_load_dwordx4 v[44:47], v4, s[8:11], s17 offen offset:0
    v_mov_b32 v7, 0xf149f2ca
    v_lshlrev_b32 v5, 2, v3
    v_sub_u32 v5, v2, v5
    v_mov_b32 v94, 0xffff0000
    v_cmp_gt_i32 s[24:25], 0, v5
    v_cmp_gt_i32 s[26:27], 1, v5
    v_cmp_gt_i32 s[28:29], 2, v5
    v_cmp_gt_i32 s[30:31], 3, v5
    v_cmp_gt_i32 s[32:33], 8, v5
    v_cmp_gt_i32 s[34:35], 9, v5
    v_cmp_gt_i32 s[36:37], 10, v5
    v_cmp_gt_i32 s[38:39], 11, v5
    v_cmp_gt_i32 s[40:41], 16, v5
    v_cmp_gt_i32 s[42:43], 17, v5
    v_cmp_gt_i32 s[44:45], 18, v5
    v_cmp_gt_i32 s[46:47], 19, v5
    v_cmp_gt_i32 s[48:49], 24, v5
    v_cmp_gt_i32 s[50:51], 25, v5
    v_cmp_gt_i32 s[52:53], 26, v5
    v_cmp_gt_i32 s[54:55], 27, v5
    v_cndmask_b32 v86, 0, v94, s[26:27]
    v_cndmask_b32 v87, 0, v94, s[30:31]
    v_cndmask_b32 v88, 0, v94, s[34:35]
    v_cndmask_b32 v89, 0, v94, s[38:39]
    v_cndmask_b32 v90, 0, v94, s[42:43]
    v_cndmask_b32 v91, 0, v94, s[46:47]
    v_cndmask_b32 v92, 0, v94, s[50:51]
    v_cndmask_b32 v93, 0, v94, s[54:55]
    v_cndmask_b32 v86, v86, -1, s[24:25]
    v_cndmask_b32 v87, v87, -1, s[28:29]
    v_cndmask_b32 v88, v88, -1, s[32:33]
    v_cndmask_b32 v89, v89, -1, s[36:37]
    v_cndmask_b32 v90, v90, -1, s[40:41]
    v_cndmask_b32 v91, v91, -1, s[44:45]
    v_cndmask_b32 v92, v92, -1, s[48:49]
    v_cndmask_b32 v93, v93, -1, s[52:53]
    s_waitcnt vmcnt(8)
    v_mfma_f32_32x32x16_bf16 v[96:111], v[12:15], v[8:11], 0
    s_waitcnt vmcnt(7)
    v_mfma_f32_32x32x16_bf16 v[112:127], v[16:19], v[8:11], 0
    s_waitcnt vmcnt(6)
    v_mfma_f32_32x32x16_bf16 v[128:143], v[20:23], v[8:11], 0
    s_waitcnt vmcnt(5)
    v_mfma_f32_32x32x16_bf16 v[144:159], v[24:27], v[8:11], 0
    s_waitcnt vmcnt(4)
    v_mfma_f32_32x32x16_bf16 v[160:175], v[28:31], v[8:11], 0
    s_waitcnt vmcnt(3)
    v_mfma_f32_32x32x16_bf16 v[176:191], v[32:35], v[8:11], 0
    s_waitcnt vmcnt(2)
    v_mfma_f32_32x32x16_bf16 v[192:207], v[36:39], v[8:11], 0
    s_waitcnt vmcnt(1)
    v_mfma_f32_32x32x16_bf16 v[208:223], v[40:43], v[8:11], 0
    s_waitcnt vmcnt(0)
    v_mfma_f32_32x32x16_bf16 v[224:239], v[44:47], v[8:11], 0
    s_add_u32 s17, s15, 20963328
    s_sub_u32 s18, 27262976, s17
    s_add_u32 s19, s18, 0x4000
    v_and_b32 v5, 27, v2
    v_cmp_eq_u32 vcc, 16, v5
    v_mov_b32 v5, s19
    v_mov_b32 v6, s18
    v_cndmask_b32 v5, v5, v6, vcc
    v_lshlrev_b32 v6, 16, v1
    v_lshl_add_u32 v6, v2, 4, v6
    v_lshl_add_u32 v6, v3, 8, v6
    v_cmp_gt_u32 vcc, 16, v2
    s_nop 7
    v_cndmask_b32 v6, v5, v6, vcc
    buffer_load_dwordx4 v[12:15], v6, s[8:11], s17 offen offset:0
    buffer_load_dwordx4 v[16:19], v6, s[8:11], s17 offen offset:512
    buffer_load_dwordx4 v[20:23], v6, s[8:11], s17 offen offset:1024
    buffer_load_dwordx4 v[24:27], v6, s[8:11], s17 offen offset:1536
    buffer_load_dwordx4 v[28:31], v6, s[8:11], s17 offen offset:2048
    buffer_load_dwordx4 v[32:35], v6, s[8:11], s17 offen offset:2560
    buffer_load_dwordx4 v[36:39], v6, s[8:11], s17 offen offset:3072
    buffer_load_dwordx4 v[40:43], v6, s[8:11], s17 offen offset:3584
    s_add_u32 s17, s17, 4096
    buffer_load_dwordx4 v[44:47], v6, s[8:11], s17 offen offset:0
    buffer_load_dwordx4 v[48:51], v6, s[8:11], s17 offen offset:512
    buffer_load_dwordx4 v[52:55], v6, s[8:11], s17 offen offset:1024
    buffer_load_dwordx4 v[56:59], v6, s[8:11], s17 offen offset:1536
    buffer_load_dwordx4 v[60:63], v6, s[8:11], s17 offen offset:2048
    buffer_load_dwordx4 v[64:67], v6, s[8:11], s17 offen offset:2560
    buffer_load_dwordx4 v[68:71], v6, s[8:11], s17 offen offset:3072
    buffer_load_dwordx4 v[72:75], v6, s[8:11], s17 offen offset:3584
    s_add_u32 s17, s17, 4096
    buffer_load_dwordx4 v[76:79], v6, s[8:11], s17 offen offset:0
    buffer_load_dwordx4 v[80:83], v6, s[8:11], s17 offen offset:512
    s_cmp_ge_u32 s12, 8
    s_cbranch_scc1 attn1_kernel_mk
    v_mov_b32 v96, v7
    v_mov_b32 v97, v7
    v_mov_b32 v98, v7
    v_mov_b32 v99, v7
    v_mov_b32 v100, v7
    v_mov_b32 v101, v7
    v_mov_b32 v102, v7
    v_mov_b32 v103, v7
    v_mov_b32 v104, v7
    v_mov_b32 v105, v7
    v_mov_b32 v106, v7
    v_mov_b32 v107, v7
    v_mov_b32 v108, v7
    v_mov_b32 v109, v7
    v_mov_b32 v110, v7
    v_mov_b32 v111, v7
    s_cmp_ge_u32 s12, 7
    s_cbranch_scc1 attn1_kernel_mk
    v_mov_b32 v112, v7
    v_mov_b32 v113, v7
    v_mov_b32 v114, v7
    v_mov_b32 v115, v7
    v_mov_b32 v116, v7
    v_mov_b32 v117, v7
    v_mov_b32 v118, v7
    v_mov_b32 v119, v7
    v_mov_b32 v120, v7
    v_mov_b32 v121, v7
    v_mov_b32 v122, v7
    v_mov_b32 v123, v7
    v_mov_b32 v124, v7
    v_mov_b32 v125, v7
    v_mov_b32 v126, v7
    v_mov_b32 v127, v7
    s_cmp_ge_u32 s12, 6
    s_cbranch_scc1 attn1_kernel_mk
    v_mov_b32 v128, v7
    v_mov_b32 v129, v7
    v_mov_b32 v130, v7
    v_mov_b32 v131, v7
    v_mov_b32 v132, v7
    v_mov_b32 v133, v7
    v_mov_b32 v134, v7
    v_mov_b32 v135, v7
    v_mov_b32 v136, v7
    v_mov_b32 v137, v7
    v_mov_b32 v138, v7
    v_mov_b32 v139, v7
    v_mov_b32 v140, v7
    v_mov_b32 v141, v7
    v_mov_b32 v142, v7
    v_mov_b32 v143, v7
    s_cmp_ge_u32 s12, 5
    s_cbranch_scc1 attn1_kernel_mk
    v_mov_b32 v144, v7
    v_mov_b32 v145, v7
    v_mov_b32 v146, v7
    v_mov_b32 v147, v7
    v_mov_b32 v148, v7
    v_mov_b32 v149, v7
    v_mov_b32 v150, v7
    v_mov_b32 v151, v7
    v_mov_b32 v152, v7
    v_mov_b32 v153, v7
    v_mov_b32 v154, v7
    v_mov_b32 v155, v7
    v_mov_b32 v156, v7
    v_mov_b32 v157, v7
    v_mov_b32 v158, v7
    v_mov_b32 v159, v7
    s_cmp_ge_u32 s12, 4
    s_cbranch_scc1 attn1_kernel_mk
    v_mov_b32 v160, v7
    v_mov_b32 v161, v7
    v_mov_b32 v162, v7
    v_mov_b32 v163, v7
    v_mov_b32 v164, v7
    v_mov_b32 v165, v7
    v_mov_b32 v166, v7
    v_mov_b32 v167, v7
    v_mov_b32 v168, v7
    v_mov_b32 v169, v7
    v_mov_b32 v170, v7
    v_mov_b32 v171, v7
    v_mov_b32 v172, v7
    v_mov_b32 v173, v7
    v_mov_b32 v174, v7
    v_mov_b32 v175, v7
    s_cmp_ge_u32 s12, 3
    s_cbranch_scc1 attn1_kernel_mk
    v_mov_b32 v176, v7
    v_mov_b32 v177, v7
    v_mov_b32 v178, v7
    v_mov_b32 v179, v7
    v_mov_b32 v180, v7
    v_mov_b32 v181, v7
    v_mov_b32 v182, v7
    v_mov_b32 v183, v7
    v_mov_b32 v184, v7
    v_mov_b32 v185, v7
    v_mov_b32 v186, v7
    v_mov_b32 v187, v7
    v_mov_b32 v188, v7
    v_mov_b32 v189, v7
    v_mov_b32 v190, v7
    v_mov_b32 v191, v7
    s_cmp_ge_u32 s12, 2
    s_cbranch_scc1 attn1_kernel_mk
    v_mov_b32 v192, v7
    v_mov_b32 v193, v7
    v_mov_b32 v194, v7
    v_mov_b32 v195, v7
    v_mov_b32 v196, v7
    v_mov_b32 v197, v7
    v_mov_b32 v198, v7
    v_mov_b32 v199, v7
    v_mov_b32 v200, v7
    v_mov_b32 v201, v7
    v_mov_b32 v202, v7
    v_mov_b32 v203, v7
    v_mov_b32 v204, v7
    v_mov_b32 v205, v7
    v_mov_b32 v206, v7
    v_mov_b32 v207, v7
    s_cmp_ge_u32 s12, 1
    s_cbranch_scc1 attn1_kernel_mk
    v_mov_b32 v208, v7
    v_mov_b32 v209, v7
    v_mov_b32 v210, v7
    v_mov_b32 v211, v7
    v_mov_b32 v212, v7
    v_mov_b32 v213, v7
    v_mov_b32 v214, v7
    v_mov_b32 v215, v7
    v_mov_b32 v216, v7
    v_mov_b32 v217, v7
    v_mov_b32 v218, v7
    v_mov_b32 v219, v7
    v_mov_b32 v220, v7
    v_mov_b32 v221, v7
    v_mov_b32 v222, v7
    v_mov_b32 v223, v7
attn1_kernel_mk:
    v_cndmask_b32 v96, v224, v96, s[24:25]
    v_cndmask_b32 v97, v225, v97, s[26:27]
    v_cndmask_b32 v98, v226, v98, s[28:29]
    v_cndmask_b32 v99, v227, v99, s[30:31]
    v_cndmask_b32 v100, v228, v100, s[32:33]
    v_cndmask_b32 v101, v229, v101, s[34:35]
    v_cndmask_b32 v102, v230, v102, s[36:37]
    v_cndmask_b32 v103, v231, v103, s[38:39]
    v_cndmask_b32 v104, v232, v104, s[40:41]
    v_cndmask_b32 v105, v233, v105, s[42:43]
    v_cndmask_b32 v106, v234, v106, s[44:45]
    v_cndmask_b32 v107, v235, v107, s[46:47]
    v_cndmask_b32 v108, v236, v108, s[48:49]
    v_cndmask_b32 v109, v237, v109, s[50:51]
    v_cndmask_b32 v110, v238, v110, s[52:53]
    v_cndmask_b32 v111, v239, v111, s[54:55]
    v_max3_f32 v84, v112, v113, v114
    v_max3_f32 v84, v84, v115, v116
    v_max3_f32 v84, v84, v117, v118
    v_max3_f32 v84, v84, v119, v120
    v_max3_f32 v84, v84, v121, v122
    v_max3_f32 v84, v84, v123, v124
    v_max3_f32 v84, v84, v125, v126
    v_max3_f32 v84, v84, v127, v128
    v_max3_f32 v84, v84, v129, v130
    v_max3_f32 v84, v84, v131, v132
    v_max3_f32 v84, v84, v133, v134
    v_max3_f32 v84, v84, v135, v136
    v_max3_f32 v84, v84, v137, v138
    v_max3_f32 v84, v84, v139, v140
    v_max3_f32 v84, v84, v141, v142
    v_max3_f32 v84, v84, v143, v144
    v_max3_f32 v84, v84, v145, v146
    v_max3_f32 v84, v84, v147, v148
    v_max3_f32 v84, v84, v149, v150
    v_max3_f32 v84, v84, v151, v152
    v_max3_f32 v84, v84, v153, v154
    v_max3_f32 v84, v84, v155, v156
    v_max3_f32 v84, v84, v157, v158
    v_max3_f32 v84, v84, v159, v160
    v_max3_f32 v84, v84, v161, v162
    v_max3_f32 v84, v84, v163, v164
    v_max3_f32 v84, v84, v165, v166
    v_max3_f32 v84, v84, v167, v168
    v_max3_f32 v84, v84, v169, v170
    v_max3_f32 v84, v84, v171, v172
    v_max3_f32 v84, v84, v173, v174
    v_max3_f32 v84, v84, v175, v176
    v_max3_f32 v84, v84, v177, v178
    v_max3_f32 v84, v84, v179, v180
    v_max3_f32 v84, v84, v181, v182
    v_max3_f32 v84, v84, v183, v184
    v_max3_f32 v84, v84, v185, v186
    v_max3_f32 v84, v84, v187, v188
    v_max3_f32 v84, v84, v189, v190
    v_max3_f32 v84, v84, v191, v192
    v_max3_f32 v84, v84, v193, v194
    v_max3_f32 v84, v84, v195, v196
    v_max3_f32 v84, v84, v197, v198
    v_max3_f32 v84, v84, v199, v200
    v_max3_f32 v84, v84, v201, v202
    v_max3_f32 v84, v84, v203, v204
    v_max3_f32 v84, v84, v205, v206
    v_max3_f32 v84, v84, v207, v208
    v_max3_f32 v84, v84, v209, v210
    v_max3_f32 v84, v84, v211, v212
    v_max3_f32 v84, v84, v213, v214
    v_max3_f32 v84, v84, v215, v216
    v_max3_f32 v84, v84, v217, v218
    v_max3_f32 v84, v84, v219, v220
    v_max3_f32 v84, v84, v221, v222
    v_max_f32 v84, v84, v223
    v_max3_f32 v84, v84, v96, v97
    v_max3_f32 v84, v84, v98, v99
    v_max3_f32 v84, v84, v100, v101
    v_max3_f32 v84, v84, v102, v103
    v_max3_f32 v84, v84, v104, v105
    v_max3_f32 v84, v84, v106, v107
    v_max3_f32 v84, v84, v108, v109
    v_max3_f32 v84, v84, v110, v111
    v_mov_b32 v85, v84
    s_nop 1
    v_permlane32_swap_b32 v84, v85
    v_max_f32 v84, v84, v85
    s_mov_b32 s22, 0x3eb8aa3b
    s_mov_b32 s23, 0x3eb8aa3b
    v_mul_f32 v84, s22, v84
    v_mov_b32 v85, v84
    v_mov_b32 v240, 0
    v_mov_b32 v241, 0
    v_mov_b32 v242, 0
    v_mov_b32 v243, 0
    v_mov_b32 v244, 0
    v_mov_b32 v245, 0
    v_mov_b32 v246, 0
    v_mov_b32 v247, 0
    v_mov_b32 v248, 0
    v_mov_b32 v249, 0
    v_mov_b32 v250, 0
    v_mov_b32 v251, 0
    v_mov_b32 v252, 0
    v_mov_b32 v253, 0
    v_mov_b32 v254, 0
    v_mov_b32 v255, 0
    v_pk_fma_f32 v[96:97], v[96:97], s[22:23], v[84:85] neg_lo:[0,0,1] neg_hi:[0,0,1]
    v_pk_fma_f32 v[98:99], v[98:99], s[22:23], v[84:85] neg_lo:[0,0,1] neg_hi:[0,0,1]
    v_pk_fma_f32 v[100:101], v[100:101], s[22:23], v[84:85] neg_lo:[0,0,1] neg_hi:[0,0,1]
    v_pk_fma_f32 v[102:103], v[102:103], s[22:23], v[84:85] neg_lo:[0,0,1] neg_hi:[0,0,1]
    v_pk_fma_f32 v[104:105], v[104:105], s[22:23], v[84:85] neg_lo:[0,0,1] neg_hi:[0,0,1]
    v_pk_fma_f32 v[106:107], v[106:107], s[22:23], v[84:85] neg_lo:[0,0,1] neg_hi:[0,0,1]
    v_pk_fma_f32 v[108:109], v[108:109], s[22:23], v[84:85] neg_lo:[0,0,1] neg_hi:[0,0,1]
    v_pk_fma_f32 v[110:111], v[110:111], s[22:23], v[84:85] neg_lo:[0,0,1] neg_hi:[0,0,1]
    v_exp_f32 v96, v96
    v_exp_f32 v97, v97
    v_exp_f32 v98, v98
    v_exp_f32 v99, v99
    v_exp_f32 v100, v100
    v_exp_f32 v101, v101
    v_exp_f32 v102, v102
    v_exp_f32 v103, v103
    v_exp_f32 v104, v104
    v_exp_f32 v105, v105
    v_exp_f32 v106, v106
    v_exp_f32 v107, v107
    v_exp_f32 v108, v108
    v_exp_f32 v109, v109
    v_exp_f32 v110, v110
    v_exp_f32 v111, v111
    s_nop 0
    v_cvt_pk_bf16_f32 v96, v96, v97
    v_cvt_pk_bf16_f32 v97, v98, v99
    v_cvt_pk_bf16_f32 v98, v100, v101
    v_cvt_pk_bf16_f32 v99, v102, v103
    v_cvt_pk_bf16_f32 v100, v104, v105
    v_cvt_pk_bf16_f32 v101, v106, v107
    v_cvt_pk_bf16_f32 v102, v108, v109
    v_cvt_pk_bf16_f32 v103, v110, v111
    v_and_b32 v104, v96, v86
    v_and_b32 v105, v97, v87
    v_and_b32 v106, v98, v88
    v_and_b32 v107, v99, v89
    v_and_b32 v108, v100, v90
    v_and_b32 v109, v101, v91
    v_and_b32 v110, v102, v92
    v_and_b32 v111, v103, v93
    v_xor_b32 v224, v96, v104
    v_xor_b32 v225, v97, v105
    v_xor_b32 v226, v98, v106
    v_xor_b32 v227, v99, v107
    v_xor_b32 v228, v100, v108
    v_xor_b32 v229, v101, v109
    v_xor_b32 v230, v102, v110
    v_xor_b32 v231, v103, v111
    s_waitcnt vmcnt(16)
    s_nop 1
    v_mfma_f32_32x32x16_bf16 v[240:255], v[12:15], v[104:107], v[240:255]
    v_mfma_f32_32x32x16_bf16 v[240:255], v[16:19], v[108:111], v[240:255]
    v_pk_fma_f32 v[112:113], v[112:113], s[22:23], v[84:85] neg_lo:[0,0,1] neg_hi:[0,0,1]
    v_pk_fma_f32 v[114:115], v[114:115], s[22:23], v[84:85] neg_lo:[0,0,1] neg_hi:[0,0,1]
    v_pk_fma_f32 v[116:117], v[116:117], s[22:23], v[84:85] neg_lo:[0,0,1] neg_hi:[0,0,1]
    v_pk_fma_f32 v[118:119], v[118:119], s[22:23], v[84:85] neg_lo:[0,0,1] neg_hi:[0,0,1]
    v_pk_fma_f32 v[120:121], v[120:121], s[22:23], v[84:85] neg_lo:[0,0,1] neg_hi:[0,0,1]
    v_pk_fma_f32 v[122:123], v[122:123], s[22:23], v[84:85] neg_lo:[0,0,1] neg_hi:[0,0,1]
    v_pk_fma_f32 v[124:125], v[124:125], s[22:23], v[84:85] neg_lo:[0,0,1] neg_hi:[0,0,1]
    v_pk_fma_f32 v[126:127], v[126:127], s[22:23], v[84:85] neg_lo:[0,0,1] neg_hi:[0,0,1]
    v_exp_f32 v112, v112
    v_exp_f32 v113, v113
    v_exp_f32 v114, v114
    v_exp_f32 v115, v115
    v_exp_f32 v116, v116
    v_exp_f32 v117, v117
    v_exp_f32 v118, v118
    v_exp_f32 v119, v119
    v_exp_f32 v120, v120
    v_exp_f32 v121, v121
    v_exp_f32 v122, v122
    v_exp_f32 v123, v123
    v_exp_f32 v124, v124
    v_exp_f32 v125, v125
    v_exp_f32 v126, v126
    v_exp_f32 v127, v127
    s_nop 0
    v_cvt_pk_bf16_f32 v112, v112, v113
    v_cvt_pk_bf16_f32 v113, v114, v115
    v_cvt_pk_bf16_f32 v114, v116, v117
    v_cvt_pk_bf16_f32 v115, v118, v119
    v_cvt_pk_bf16_f32 v116, v120, v121
    v_cvt_pk_bf16_f32 v117, v122, v123
    v_cvt_pk_bf16_f32 v118, v124, v125
    v_cvt_pk_bf16_f32 v119, v126, v127
    s_waitcnt vmcnt(14)
    s_nop 1
    v_mfma_f32_32x32x16_bf16 v[240:255], v[20:23], v[112:115], v[240:255]
    v_mfma_f32_32x32x16_bf16 v[240:255], v[24:27], v[116:119], v[240:255]
    v_pk_fma_f32 v[128:129], v[128:129], s[22:23], v[84:85] neg_lo:[0,0,1] neg_hi:[0,0,1]
    v_pk_fma_f32 v[130:131], v[130:131], s[22:23], v[84:85] neg_lo:[0,0,1] neg_hi:[0,0,1]
    v_pk_fma_f32 v[132:133], v[132:133], s[22:23], v[84:85] neg_lo:[0,0,1] neg_hi:[0,0,1]
    v_pk_fma_f32 v[134:135], v[134:135], s[22:23], v[84:85] neg_lo:[0,0,1] neg_hi:[0,0,1]
    v_pk_fma_f32 v[136:137], v[136:137], s[22:23], v[84:85] neg_lo:[0,0,1] neg_hi:[0,0,1]
    v_pk_fma_f32 v[138:139], v[138:139], s[22:23], v[84:85] neg_lo:[0,0,1] neg_hi:[0,0,1]
    v_pk_fma_f32 v[140:141], v[140:141], s[22:23], v[84:85] neg_lo:[0,0,1] neg_hi:[0,0,1]
    v_pk_fma_f32 v[142:143], v[142:143], s[22:23], v[84:85] neg_lo:[0,0,1] neg_hi:[0,0,1]
    v_exp_f32 v128, v128
    v_exp_f32 v129, v129
    v_exp_f32 v130, v130
    v_exp_f32 v131, v131
    v_exp_f32 v132, v132
    v_exp_f32 v133, v133
    v_exp_f32 v134, v134
    v_exp_f32 v135, v135
    v_exp_f32 v136, v136
    v_exp_f32 v137, v137
    v_exp_f32 v138, v138
    v_exp_f32 v139, v139
    v_exp_f32 v140, v140
    v_exp_f32 v141, v141
    v_exp_f32 v142, v142
    v_exp_f32 v143, v143
    s_nop 0
    v_cvt_pk_bf16_f32 v128, v128, v129
    v_cvt_pk_bf16_f32 v129, v130, v131
    v_cvt_pk_bf16_f32 v130, v132, v133
    v_cvt_pk_bf16_f32 v131, v134, v135
    v_cvt_pk_bf16_f32 v132, v136, v137
    v_cvt_pk_bf16_f32 v133, v138, v139
    v_cvt_pk_bf16_f32 v134, v140, v141
    v_cvt_pk_bf16_f32 v135, v142, v143
    s_waitcnt vmcnt(12)
    s_nop 1
    v_mfma_f32_32x32x16_bf16 v[240:255], v[28:31], v[128:131], v[240:255]
    v_mfma_f32_32x32x16_bf16 v[240:255], v[32:35], v[132:135], v[240:255]
    v_pk_fma_f32 v[144:145], v[144:145], s[22:23], v[84:85] neg_lo:[0,0,1] neg_hi:[0,0,1]
    v_pk_fma_f32 v[146:147], v[146:147], s[22:23], v[84:85] neg_lo:[0,0,1] neg_hi:[0,0,1]
    v_pk_fma_f32 v[148:149], v[148:149], s[22:23], v[84:85] neg_lo:[0,0,1] neg_hi:[0,0,1]
    v_pk_fma_f32 v[150:151], v[150:151], s[22:23], v[84:85] neg_lo:[0,0,1] neg_hi:[0,0,1]
    v_pk_fma_f32 v[152:153], v[152:153], s[22:23], v[84:85] neg_lo:[0,0,1] neg_hi:[0,0,1]
    v_pk_fma_f32 v[154:155], v[154:155], s[22:23], v[84:85] neg_lo:[0,0,1] neg_hi:[0,0,1]
    v_pk_fma_f32 v[156:157], v[156:157], s[22:23], v[84:85] neg_lo:[0,0,1] neg_hi:[0,0,1]
    v_pk_fma_f32 v[158:159], v[158:159], s[22:23], v[84:85] neg_lo:[0,0,1] neg_hi:[0,0,1]
    v_exp_f32 v144, v144
    v_exp_f32 v145, v145
    v_exp_f32 v146, v146
    v_exp_f32 v147, v147
    v_exp_f32 v148, v148
    v_exp_f32 v149, v149
    v_exp_f32 v150, v150
    v_exp_f32 v151, v151
    v_exp_f32 v152, v152
    v_exp_f32 v153, v153
    v_exp_f32 v154, v154
    v_exp_f32 v155, v155
    v_exp_f32 v156, v156
    v_exp_f32 v157, v157
    v_exp_f32 v158, v158
    v_exp_f32 v159, v159
    s_nop 0
    v_cvt_pk_bf16_f32 v144, v144, v145
    v_cvt_pk_bf16_f32 v145, v146, v147
    v_cvt_pk_bf16_f32 v146, v148, v149
    v_cvt_pk_bf16_f32 v147, v150, v151
    v_cvt_pk_bf16_f32 v148, v152, v153
    v_cvt_pk_bf16_f32 v149, v154, v155
    v_cvt_pk_bf16_f32 v150, v156, v157
    v_cvt_pk_bf16_f32 v151, v158, v159
    s_waitcnt vmcnt(10)
    s_nop 1
    v_mfma_f32_32x32x16_bf16 v[240:255], v[36:39], v[144:147], v[240:255]
    v_mfma_f32_32x32x16_bf16 v[240:255], v[40:43], v[148:151], v[240:255]
    v_pk_fma_f32 v[160:161], v[160:161], s[22:23], v[84:85] neg_lo:[0,0,1] neg_hi:[0,0,1]
    v_pk_fma_f32 v[162:163], v[162:163], s[22:23], v[84:85] neg_lo:[0,0,1] neg_hi:[0,0,1]
    v_pk_fma_f32 v[164:165], v[164:165], s[22:23], v[84:85] neg_lo:[0,0,1] neg_hi:[0,0,1]
    v_pk_fma_f32 v[166:167], v[166:167], s[22:23], v[84:85] neg_lo:[0,0,1] neg_hi:[0,0,1]
    v_pk_fma_f32 v[168:169], v[168:169], s[22:23], v[84:85] neg_lo:[0,0,1] neg_hi:[0,0,1]
    v_pk_fma_f32 v[170:171], v[170:171], s[22:23], v[84:85] neg_lo:[0,0,1] neg_hi:[0,0,1]
    v_pk_fma_f32 v[172:173], v[172:173], s[22:23], v[84:85] neg_lo:[0,0,1] neg_hi:[0,0,1]
    v_pk_fma_f32 v[174:175], v[174:175], s[22:23], v[84:85] neg_lo:[0,0,1] neg_hi:[0,0,1]
    v_exp_f32 v160, v160
    v_exp_f32 v161, v161
    v_exp_f32 v162, v162
    v_exp_f32 v163, v163
    v_exp_f32 v164, v164
    v_exp_f32 v165, v165
    v_exp_f32 v166, v166
    v_exp_f32 v167, v167
    v_exp_f32 v168, v168
    v_exp_f32 v169, v169
    v_exp_f32 v170, v170
    v_exp_f32 v171, v171
    v_exp_f32 v172, v172
    v_exp_f32 v173, v173
    v_exp_f32 v174, v174
    v_exp_f32 v175, v175
    s_nop 0
    v_cvt_pk_bf16_f32 v160, v160, v161
    v_cvt_pk_bf16_f32 v161, v162, v163
    v_cvt_pk_bf16_f32 v162, v164, v165
    v_cvt_pk_bf16_f32 v163, v166, v167
    v_cvt_pk_bf16_f32 v164, v168, v169
    v_cvt_pk_bf16_f32 v165, v170, v171
    v_cvt_pk_bf16_f32 v166, v172, v173
    v_cvt_pk_bf16_f32 v167, v174, v175
    s_waitcnt vmcnt(8)
    s_nop 1
    v_mfma_f32_32x32x16_bf16 v[240:255], v[44:47], v[160:163], v[240:255]
    v_mfma_f32_32x32x16_bf16 v[240:255], v[48:51], v[164:167], v[240:255]
    v_pk_fma_f32 v[176:177], v[176:177], s[22:23], v[84:85] neg_lo:[0,0,1] neg_hi:[0,0,1]
    v_pk_fma_f32 v[178:179], v[178:179], s[22:23], v[84:85] neg_lo:[0,0,1] neg_hi:[0,0,1]
    v_pk_fma_f32 v[180:181], v[180:181], s[22:23], v[84:85] neg_lo:[0,0,1] neg_hi:[0,0,1]
    v_pk_fma_f32 v[182:183], v[182:183], s[22:23], v[84:85] neg_lo:[0,0,1] neg_hi:[0,0,1]
    v_pk_fma_f32 v[184:185], v[184:185], s[22:23], v[84:85] neg_lo:[0,0,1] neg_hi:[0,0,1]
    v_pk_fma_f32 v[186:187], v[186:187], s[22:23], v[84:85] neg_lo:[0,0,1] neg_hi:[0,0,1]
    v_pk_fma_f32 v[188:189], v[188:189], s[22:23], v[84:85] neg_lo:[0,0,1] neg_hi:[0,0,1]
    v_pk_fma_f32 v[190:191], v[190:191], s[22:23], v[84:85] neg_lo:[0,0,1] neg_hi:[0,0,1]
    v_exp_f32 v176, v176
    v_exp_f32 v177, v177
    v_exp_f32 v178, v178
    v_exp_f32 v179, v179
    v_exp_f32 v180, v180
    v_exp_f32 v181, v181
    v_exp_f32 v182, v182
    v_exp_f32 v183, v183
    v_exp_f32 v184, v184
    v_exp_f32 v185, v185
    v_exp_f32 v186, v186
    v_exp_f32 v187, v187
    v_exp_f32 v188, v188
    v_exp_f32 v189, v189
    v_exp_f32 v190, v190
    v_exp_f32 v191, v191
    s_nop 0
    v_cvt_pk_bf16_f32 v176, v176, v177
    v_cvt_pk_bf16_f32 v177, v178, v179
    v_cvt_pk_bf16_f32 v178, v180, v181
    v_cvt_pk_bf16_f32 v179, v182, v183
    v_cvt_pk_bf16_f32 v180, v184, v185
    v_cvt_pk_bf16_f32 v181, v186, v187
    v_cvt_pk_bf16_f32 v182, v188, v189
    v_cvt_pk_bf16_f32 v183, v190, v191
    s_waitcnt vmcnt(6)
    s_nop 1
    v_mfma_f32_32x32x16_bf16 v[240:255], v[52:55], v[176:179], v[240:255]
    v_mfma_f32_32x32x16_bf16 v[240:255], v[56:59], v[180:183], v[240:255]
    v_pk_fma_f32 v[192:193], v[192:193], s[22:23], v[84:85] neg_lo:[0,0,1] neg_hi:[0,0,1]
    v_pk_fma_f32 v[194:195], v[194:195], s[22:23], v[84:85] neg_lo:[0,0,1] neg_hi:[0,0,1]
    v_pk_fma_f32 v[196:197], v[196:197], s[22:23], v[84:85] neg_lo:[0,0,1] neg_hi:[0,0,1]
    v_pk_fma_f32 v[198:199], v[198:199], s[22:23], v[84:85] neg_lo:[0,0,1] neg_hi:[0,0,1]
    v_pk_fma_f32 v[200:201], v[200:201], s[22:23], v[84:85] neg_lo:[0,0,1] neg_hi:[0,0,1]
    v_pk_fma_f32 v[202:203], v[202:203], s[22:23], v[84:85] neg_lo:[0,0,1] neg_hi:[0,0,1]
    v_pk_fma_f32 v[204:205], v[204:205], s[22:23], v[84:85] neg_lo:[0,0,1] neg_hi:[0,0,1]
    v_pk_fma_f32 v[206:207], v[206:207], s[22:23], v[84:85] neg_lo:[0,0,1] neg_hi:[0,0,1]
    v_exp_f32 v192, v192
    v_exp_f32 v193, v193
    v_exp_f32 v194, v194
    v_exp_f32 v195, v195
    v_exp_f32 v196, v196
    v_exp_f32 v197, v197
    v_exp_f32 v198, v198
    v_exp_f32 v199, v199
    v_exp_f32 v200, v200
    v_exp_f32 v201, v201
    v_exp_f32 v202, v202
    v_exp_f32 v203, v203
    v_exp_f32 v204, v204
    v_exp_f32 v205, v205
    v_exp_f32 v206, v206
    v_exp_f32 v207, v207
    s_nop 0
    v_cvt_pk_bf16_f32 v192, v192, v193
    v_cvt_pk_bf16_f32 v193, v194, v195
    v_cvt_pk_bf16_f32 v194, v196, v197
    v_cvt_pk_bf16_f32 v195, v198, v199
    v_cvt_pk_bf16_f32 v196, v200, v201
    v_cvt_pk_bf16_f32 v197, v202, v203
    v_cvt_pk_bf16_f32 v198, v204, v205
    v_cvt_pk_bf16_f32 v199, v206, v207
    s_waitcnt vmcnt(4)
    s_nop 1
    v_mfma_f32_32x32x16_bf16 v[240:255], v[60:63], v[192:195], v[240:255]
    v_mfma_f32_32x32x16_bf16 v[240:255], v[64:67], v[196:199], v[240:255]
    v_pk_fma_f32 v[208:209], v[208:209], s[22:23], v[84:85] neg_lo:[0,0,1] neg_hi:[0,0,1]
    v_pk_fma_f32 v[210:211], v[210:211], s[22:23], v[84:85] neg_lo:[0,0,1] neg_hi:[0,0,1]
    v_pk_fma_f32 v[212:213], v[212:213], s[22:23], v[84:85] neg_lo:[0,0,1] neg_hi:[0,0,1]
    v_pk_fma_f32 v[214:215], v[214:215], s[22:23], v[84:85] neg_lo:[0,0,1] neg_hi:[0,0,1]
    v_pk_fma_f32 v[216:217], v[216:217], s[22:23], v[84:85] neg_lo:[0,0,1] neg_hi:[0,0,1]
    v_pk_fma_f32 v[218:219], v[218:219], s[22:23], v[84:85] neg_lo:[0,0,1] neg_hi:[0,0,1]
    v_pk_fma_f32 v[220:221], v[220:221], s[22:23], v[84:85] neg_lo:[0,0,1] neg_hi:[0,0,1]
    v_pk_fma_f32 v[222:223], v[222:223], s[22:23], v[84:85] neg_lo:[0,0,1] neg_hi:[0,0,1]
    v_exp_f32 v208, v208
    v_exp_f32 v209, v209
    v_exp_f32 v210, v210
    v_exp_f32 v211, v211
    v_exp_f32 v212, v212
    v_exp_f32 v213, v213
    v_exp_f32 v214, v214
    v_exp_f32 v215, v215
    v_exp_f32 v216, v216
    v_exp_f32 v217, v217
    v_exp_f32 v218, v218
    v_exp_f32 v219, v219
    v_exp_f32 v220, v220
    v_exp_f32 v221, v221
    v_exp_f32 v222, v222
    v_exp_f32 v223, v223
    s_nop 0
    v_cvt_pk_bf16_f32 v208, v208, v209
    v_cvt_pk_bf16_f32 v209, v210, v211
    v_cvt_pk_bf16_f32 v210, v212, v213
    v_cvt_pk_bf16_f32 v211, v214, v215
    v_cvt_pk_bf16_f32 v212, v216, v217
    v_cvt_pk_bf16_f32 v213, v218, v219
    v_cvt_pk_bf16_f32 v214, v220, v221
    v_cvt_pk_bf16_f32 v215, v222, v223
    s_waitcnt vmcnt(2)
    s_nop 1
    v_mfma_f32_32x32x16_bf16 v[240:255], v[68:71], v[208:211], v[240:255]
    v_mfma_f32_32x32x16_bf16 v[240:255], v[72:75], v[212:215], v[240:255]
    s_waitcnt vmcnt(0)
    s_nop 1
    v_mfma_f32_32x32x16_bf16 v[240:255], v[76:79], v[224:227], v[240:255]
    v_mfma_f32_32x32x16_bf16 v[240:255], v[80:83], v[228:231], v[240:255]
    v_lshlrev_b32 v4, 4, v2
    v_lshl_add_u32 v4, v1, 10, v4
    v_lshl_add_u32 v4, v3, 3, v4
    s_lshl_b32 s15, s12, 15
    s_add_u32 s16, s15, 23068672
    s_nop 7
    v_rcp_f32 v84, v248
    s_nop 0
    v_mul_f32 v240, v240, v84
    v_mul_f32 v241, v241, v84
    v_mul_f32 v242, v242, v84
    v_mul_f32 v243, v243, v84
    v_mul_f32 v244, v244, v84
    v_mul_f32 v245, v245, v84
    v_mul_f32 v246, v246, v84
    v_mul_f32 v247, v247, v84
    v_cvt_pk_bf16_f32 v240, v240, v241
    v_cvt_pk_bf16_f32 v241, v242, v243
    v_cvt_pk_bf16_f32 v242, v244, v245
    v_cvt_pk_bf16_f32 v243, v246, v247
    buffer_store_dwordx2 v[240:241], v4, s[8:11], s16 offen
    buffer_store_dwordx2 v[242:243], v4, s[8:11], s16 offen offset:512
    s_cmp_ge_u32 s2, 16
    s_cbranch_scc1 attn1_kernel_nz
    v_mov_b32 v5, 0
    s_lshl_b32 s17, s2, 10
    s_add_u32 s17, s17, 25231360
    v_lshlrev_b32 v6, 2, v0
    buffer_store_dword v5, v6, s[8:11], s17 offen
attn1_kernel_nz:
attn1_kernel_end:
    s_endpgm
.globl oproj2_kernel
.p2align 8
.type oproj2_kernel,@function
oproj2_kernel:
    s_load_dwordx2 s[4:5], s[0:1], 112
    s_load_dwordx2 s[6:7], s[0:1], 96
    s_cmp_ge_u32 s2, 256
    s_cbranch_scc1 oproj1_kernel_end
    s_mov_b32 s40, 6291456
    s_mov_b32 s42, 1
    s_branch oproj1_kernel_body
.globl oproj1_kernel
.p2align 8
.type oproj1_kernel,@function
oproj1_kernel:
    s_load_dwordx2 s[4:5], s[0:1], 112
    s_load_dwordx2 s[6:7], s[0:1], 96
    s_cmp_ge_u32 s2, 256
    s_cbranch_scc1 oproj1_kernel_end
    s_mov_b32 s40, 2097152
    s_mov_b32 s42, 0
oproj1_kernel_body:
    s_and_b32 s12, s2, 1
    s_lshl_b32 s12, s12, 3
    s_bfe_u32 s13, s2, 0x30003
    s_add_u32 s12, s12, s13
    s_bfe_u32 s13, s2, 0x20001
    s_lshl_b32 s13, s13, 2
    s_lshr_b32 s14, s2, 6
    s_add_u32 s13, s13, s14
    v_and_b32 v1, 31, v0
    v_bfe_u32 v2, v0, 5, 1
    v_lshrrev_b32 v4, 6, v0
    v_lshl_add_u32 v6, v4, 5, v1
    v_and_b32 v5, 63, v0
    v_lshlrev_b32 v5, 4, v5
    v_lshl_add_u32 v8, v4, 15, v5
    v_lshl_add_u32 v7, v4, 13, v5
    s_lshl_b32 s14, s12, 15
    s_add_u32 s14, s14, 15728640
    s_add_u32 s19, s14, 4096
    s_lshl_b32 s15, s13, 17
    s_add_u32 s15, s15, 23068672
    s_mov_b32 s10, 0x10000000
    s_mov_b32 s11, 0x00020000
    s_mov_b32 s26, 0x200000
    s_mov_b32 s27, 0x00020000
    s_waitcnt lgkmcnt(0)
    s_mov_b32 s8, s4
    s_and_b32 s9, s5, 0xffff
    s_mov_b32 s24, s6
    s_and_b32 s25, s7, 0xffff
    buffer_load_dwordx4 v[192:195], v7, s[8:11], s14 offen offset:0
    buffer_load_dwordx4 v[196:199], v7, s[8:11], s14 offen offset:1024
    buffer_load_dwordx4 v[200:203], v7, s[8:11], s14 offen offset:2048
    buffer_load_dwordx4 v[204:207], v7, s[8:11], s14 offen offset:3072
    buffer_load_dwordx4 v[208:211], v7, s[8:11], s19 offen offset:0
    buffer_load_dwordx4 v[212:215], v7, s[8:11], s19 offen offset:1024
    buffer_load_dwordx4 v[216:219], v7, s[8:11], s19 offen offset:2048
    buffer_load_dwordx4 v[220:223], v7, s[8:11], s19 offen offset:3072
    v_lshlrev_b32 v9, 14, v2
    v_lshl_add_u32 v9, v6, 1, v9
    s_lshl_b32 s16, s12, 17
    s_lshl_b32 s17, s13, 8
    s_add_u32 s16, s16, s17
    s_add_u32 s17, s16, 4194304
    s_add_u32 s16, s16, s40
    s_add_u32 s18, s16, 0
    buffer_load_ushort v32, v9, s[8:11], s18 offen
    s_add_u32 s18, s16, 4096
    buffer_load_ushort v33, v9, s[8:11], s18 offen
    s_add_u32 s18, s16, 8192
    buffer_load_ushort v34, v9, s[8:11], s18 offen
    s_add_u32 s18, s16, 12288
    buffer_load_ushort v35, v9, s[8:11], s18 offen
    s_add_u32 s18, s16, 32768
    buffer_load_ushort v36, v9, s[8:11], s18 offen
    s_add_u32 s18, s16, 36864
    buffer_load_ushort v37, v9, s[8:11], s18 offen
    s_add_u32 s18, s16, 40960
    buffer_load_ushort v38, v9, s[8:11], s18 offen
    s_add_u32 s18, s16, 45056
    buffer_load_ushort v39, v9, s[8:11], s18 offen
    s_add_u32 s18, s16, 65536
    buffer_load_ushort v40, v9, s[8:11], s18 offen
    s_add_u32 s18, s16, 69632
    buffer_load_ushort v41, v9, s[8:11], s18 offen
    s_add_u32 s18, s16, 73728
    buffer_load_ushort v42, v9, s[8:11], s18 offen
    s_add_u32 s18, s16, 77824
    buffer_load_ushort v43, v9, s[8:11], s18 offen
    s_add_u32 s18, s16, 98304
    buffer_load_ushort v44, v9, s[8:11], s18 offen
    s_add_u32 s18, s16, 102400
    buffer_load_ushort v45, v9, s[8:11], s18 offen
    s_add_u32 s18, s16, 106496
    buffer_load_ushort v46, v9, s[8:11], s18 offen
    s_add_u32 s18, s16, 110592
    buffer_load_ushort v47, v9, s[8:11], s18 offen
    buffer_load_dwordx4 v[64:67], v8, s[8:11], s15 offen offset:0
    buffer_load_dwordx4 v[68:71], v8, s[8:11], s15 offen offset:1024
    buffer_load_dwordx4 v[72:75], v8, s[8:11], s15 offen offset:2048
    buffer_load_dwordx4 v[76:79], v8, s[8:11], s15 offen offset:3072
    s_add_u32 s15, s15, 4096
    buffer_load_dwordx4 v[80:83], v8, s[8:11], s15 offen offset:0
    buffer_load_dwordx4 v[84:87], v8, s[8:11], s15 offen offset:1024
    buffer_load_dwordx4 v[88:91], v8, s[8:11], s15 offen offset:2048
    buffer_load_dwordx4 v[92:95], v8, s[8:11], s15 offen offset:3072
    s_add_u32 s15, s15, 4096
    buffer_load_dwordx4 v[96:99], v8, s[8:11], s15 offen offset:0
    buffer_load_dwordx4 v[100:103], v8, s[8:11], s15 offen offset:1024
    buffer_load_dwordx4 v[104:107], v8, s[8:11], s15 offen offset:2048
    buffer_load_dwordx4 v[108:111], v8, s[8:11], s15 offen offset:3072
    s_add_u32 s15, s15, 4096
    s_waitcnt vmcnt(35)
    ds_write_b128 v7, v[192:195] offset:0
    s_waitcnt vmcnt(34)
    ds_write_b128 v7, v[196:199] offset:1024
    s_waitcnt vmcnt(33)
    ds_write_b128 v7, v[200:203] offset:2048
    s_waitcnt vmcnt(32)
    ds_write_b128 v7, v[204:207] offset:3072
    s_waitcnt vmcnt(31)
    ds_write_b128 v7, v[208:211] offset:4096
    s_waitcnt vmcnt(30)
    ds_write_b128 v7, v[212:215] offset:5120
    s_waitcnt vmcnt(29)
    ds_write_b128 v7, v[216:219] offset:6144
    s_waitcnt vmcnt(28)
    ds_write_b128 v7, v[220:223] offset:7168
    s_waitcnt lgkmcnt(0)
    s_barrier
    ds_read_b128 a[0:3], v5 offset:0
    ds_read_b128 a[4:7], v5 offset:1024
    ds_read_b128 a[8:11], v5 offset:2048
    ds_read_b128 a[12:15], v5 offset:3072
    ds_read_b128 a[16:19], v5 offset:4096
    ds_read_b128 a[20:23], v5 offset:5120
    ds_read_b128 a[24:27], v5 offset:6144
    ds_read_b128 a[28:31], v5 offset:7168
    ds_read_b128 a[32:35], v5 offset:8192
    ds_read_b128 a[36:39], v5 offset:9216
    ds_read_b128 a[40:43], v5 offset:10240
    ds_read_b128 a[44:47], v5 offset:11264
    ds_read_b128 a[48:51], v5 offset:12288
    ds_read_b128 a[52:55], v5 offset:13312
    ds_read_b128 a[56:59], v5 offset:14336
    ds_read_b128 a[60:63], v5 offset:15360
    ds_read_b128 a[64:67], v5 offset:16384
    ds_read_b128 a[68:71], v5 offset:17408
    ds_read_b128 a[72:75], v5 offset:18432
    ds_read_b128 a[76:79], v5 offset:19456
    ds_read_b128 a[80:83], v5 offset:20480
    ds_read_b128 a[84:87], v5 offset:21504
    ds_read_b128 a[88:91], v5 offset:22528
    ds_read_b128 a[92:95], v5 offset:23552
    ds_read_b128 a[96:99], v5 offset:24576
    ds_read_b128 a[100:103], v5 offset:25600
    ds_read_b128 a[104:107], v5 offset:26624
    ds_read_b128 a[108:111], v5 offset:27648
    ds_read_b128 a[112:115], v5 offset:28672
    ds_read_b128 a[116:119], v5 offset:29696
    ds_read_b128 a[120:123], v5 offset:30720
    ds_read_b128 a[124:127], v5 offset:31744
    buffer_load_dwordx4 v[112:115], v8, s[8:11], s15 offen offset:0
    s_waitcnt vmcnt(12) lgkmcnt(15)
    v_mfma_f32_32x32x16_bf16 v[16:31], a[0:3], v[64:67], 0
    buffer_load_dwordx4 v[116:119], v8, s[8:11], s15 offen offset:1024
    s_waitcnt vmcnt(12) lgkmcnt(15)
    v_mfma_f32_32x32x16_bf16 v[16:31], a[4:7], v[68:71], v[16:31]
    buffer_load_dwordx4 v[120:123], v8, s[8:11], s15 offen offset:2048
    s_waitcnt vmcnt(12) lgkmcnt(15)
    v_mfma_f32_32x32x16_bf16 v[16:31], a[8:11], v[72:75], v[16:31]
    buffer_load_dwordx4 v[124:127], v8, s[8:11], s15 offen offset:3072
    s_add_u32 s15, s15, 4096
    s_waitcnt vmcnt(12) lgkmcnt(15)
    v_mfma_f32_32x32x16_bf16 v[16:31], a[12:15], v[76:79], v[16:31]
    buffer_load_dwordx4 v[128:131], v8, s[8:11], s15 offen offset:0
    s_waitcnt vmcnt(12) lgkmcnt(15)
    v_mfma_f32_32x32x16_bf16 v[16:31], a[16:19], v[80:83], v[16:31]
    buffer_load_dwordx4 v[132:135], v8, s[8:11], s15 offen offset:1024
    s_waitcnt vmcnt(12) lgkmcnt(15)
    v_mfma_f32_32x32x16_bf16 v[16:31], a[20:23], v[84:87], v[16:31]
    buffer_load_dwordx4 v[136:139], v8, s[8:11], s15 offen offset:2048
    s_waitcnt vmcnt(12) lgkmcnt(15)
    v_mfma_f32_32x32x16_bf16 v[16:31], a[24:27], v[88:91], v[16:31]
    buffer_load_dwordx4 v[140:143], v8, s[8:11], s15 offen offset:3072
    s_add_u32 s15, s15, 4096
    s_waitcnt vmcnt(12) lgkmcnt(15)
    v_mfma_f32_32x32x16_bf16 v[16:31], a[28:31], v[92:95], v[16:31]
    buffer_load_dwordx4 v[144:147], v8, s[8:11], s15 offen offset:0
    s_waitcnt vmcnt(12) lgkmcnt(15)
    v_mfma_f32_32x32x16_bf16 v[16:31], a[32:35], v[96:99], v[16:31]
    buffer_load_dwordx4 v[148:151], v8, s[8:11], s15 offen offset:1024
    s_waitcnt vmcnt(12) lgkmcnt(15)
    v_mfma_f32_32x32x16_bf16 v[16:31], a[36:39], v[100:103], v[16:31]
    buffer_load_dwordx4 v[152:155], v8, s[8:11], s15 offen offset:2048
    s_waitcnt vmcnt(12) lgkmcnt(15)
    v_mfma_f32_32x32x16_bf16 v[16:31], a[40:43], v[104:107], v[16:31]
    buffer_load_dwordx4 v[156:159], v8, s[8:11], s15 offen offset:3072
    s_add_u32 s15, s15, 4096
    s_waitcnt vmcnt(12) lgkmcnt(15)
    v_mfma_f32_32x32x16_bf16 v[16:31], a[44:47], v[108:111], v[16:31]
    buffer_load_dwordx4 v[160:163], v8, s[8:11], s15 offen offset:0
    s_waitcnt vmcnt(12) lgkmcnt(15)
    v_mfma_f32_32x32x16_bf16 v[16:31], a[48:51], v[112:115], v[16:31]
    buffer_load_dwordx4 v[164:167], v8, s[8:11], s15 offen offset:1024
    s_waitcnt vmcnt(12) lgkmcnt(15)
    v_mfma_f32_32x32x16_bf16 v[16:31], a[52:55], v[116:119], v[16:31]
    buffer_load_dwordx4 v[168:171], v8, s[8:11], s15 offen offset:2048
    s_waitcnt vmcnt(12) lgkmcnt(15)
    v_mfma_f32_32x32x16_bf16 v[16:31], a[56:59], v[120:123], v[16:31]
    buffer_load_dwordx4 v[172:175], v8, s[8:11], s15 offen offset:3072
    s_add_u32 s15, s15, 4096
    s_waitcnt vmcnt(12) lgkmcnt(15)
    v_mfma_f32_32x32x16_bf16 v[16:31], a[60:63], v[124:127], v[16:31]
    buffer_load_dwordx4 v[176:179], v8, s[8:11], s15 offen offset:0
    s_waitcnt vmcnt(12) lgkmcnt(15)
    v_mfma_f32_32x32x16_bf16 v[16:31], a[64:67], v[128:131], v[16:31]
    buffer_load_dwordx4 v[180:183], v8, s[8:11], s15 offen offset:1024
    s_waitcnt vmcnt(12) lgkmcnt(14)
    v_mfma_f32_32x32x16_bf16 v[16:31], a[68:71], v[132:135], v[16:31]
    buffer_load_dwordx4 v[184:187], v8, s[8:11], s15 offen offset:2048
    s_waitcnt vmcnt(12) lgkmcnt(13)
    v_mfma_f32_32x32x16_bf16 v[16:31], a[72:75], v[136:139], v[16:31]
    buffer_load_dwordx4 v[188:191], v8, s[8:11], s15 offen offset:3072
    s_waitcnt vmcnt(12) lgkmcnt(12)
    v_mfma_f32_32x32x16_bf16 v[16:31], a[76:79], v[140:143], v[16:31]
    s_waitcnt vmcnt(11) lgkmcnt(11)
    v_mfma_f32_32x32x16_bf16 v[16:31], a[80:83], v[144:147], v[16:31]
    s_waitcnt vmcnt(10) lgkmcnt(10)
    v_mfma_f32_32x32x16_bf16 v[16:31], a[84:87], v[148:151], v[16:31]
    s_waitcnt vmcnt(9) lgkmcnt(9)
    v_mfma_f32_32x32x16_bf16 v[16:31], a[88:91], v[152:155], v[16:31]
    s_waitcnt vmcnt(8) lgkmcnt(8)
    v_mfma_f32_32x32x16_bf16 v[16:31], a[92:95], v[156:159], v[16:31]
    s_waitcnt vmcnt(7) lgkmcnt(7)
    v_mfma_f32_32x32x16_bf16 v[16:31], a[96:99], v[160:163], v[16:31]
    s_waitcnt vmcnt(6) lgkmcnt(6)
    v_mfma_f32_32x32x16_bf16 v[16:31], a[100:103], v[164:167], v[16:31]
    s_waitcnt vmcnt(5) lgkmcnt(5)
    v_mfma_f32_32x32x16_bf16 v[16:31], a[104:107], v[168:171], v[16:31]
    s_waitcnt vmcnt(4) lgkmcnt(4)
    v_mfma_f32_32x32x16_bf16 v[16:31], a[108:111], v[172:175], v[16:31]
    s_waitcnt vmcnt(3) lgkmcnt(3)
    v_mfma_f32_32x32x16_bf16 v[16:31], a[112:115], v[176:179], v[16:31]
    s_waitcnt vmcnt(2) lgkmcnt(2)
    v_mfma_f32_32x32x16_bf16 v[16:31], a[116:119], v[180:183], v[16:31]
    s_waitcnt vmcnt(1) lgkmcnt(1)
    v_mfma_f32_32x32x16_bf16 v[16:31], a[120:123], v[184:187], v[16:31]
    s_waitcnt vmcnt(0) lgkmcnt(0)
    v_mfma_f32_32x32x16_bf16 v[16:31], a[124:127], v[188:191], v[16:31]
    s_waitcnt vmcnt(0)
    s_nop 7
    s_nop 3
    v_mov_b32 v50, 0
    v_mov_b32 v51, 0
    v_cvt_pk_bf16_f32 v48, v16, v17
    v_lshlrev_b32 v16, 16, v48
    v_and_b32 v17, 0xffff0000, v48
    v_lshlrev_b32 v32, 16, v32
    v_lshlrev_b32 v33, 16, v33
    v_pk_add_f32 v[16:17], v[16:17], v[32:33]
    v_cvt_pk_bf16_f32 v32, v16, v17
    v_cvt_pk_bf16_f32 v48, v18, v19
    v_lshlrev_b32 v18, 16, v48
    v_and_b32 v19, 0xffff0000, v48
    v_lshlrev_b32 v34, 16, v34
    v_lshlrev_b32 v35, 16, v35
    v_pk_add_f32 v[18:19], v[18:19], v[34:35]
    v_cvt_pk_bf16_f32 v33, v18, v19
    v_cvt_pk_bf16_f32 v48, v20, v21
    v_lshlrev_b32 v20, 16, v48
    v_and_b32 v21, 0xffff0000, v48
    v_lshlrev_b32 v36, 16, v36
    v_lshlrev_b32 v37, 16, v37
    v_pk_add_f32 v[20:21], v[20:21], v[36:37]
    v_cvt_pk_bf16_f32 v34, v20, v21
    v_cvt_pk_bf16_f32 v48, v22, v23
    v_lshlrev_b32 v22, 16, v48
    v_and_b32 v23, 0xffff0000, v48
    v_lshlrev_b32 v38, 16, v38
    v_lshlrev_b32 v39, 16, v39
    v_pk_add_f32 v[22:23], v[22:23], v[38:39]
    v_cvt_pk_bf16_f32 v35, v22, v23
    v_cvt_pk_bf16_f32 v48, v24, v25
    v_lshlrev_b32 v24, 16, v48
    v_and_b32 v25, 0xffff0000, v48
    v_lshlrev_b32 v40, 16, v40
    v_lshlrev_b32 v41, 16, v41
    v_pk_add_f32 v[24:25], v[24:25], v[40:41]
    v_cvt_pk_bf16_f32 v36, v24, v25
    v_cvt_pk_bf16_f32 v48, v26, v27
    v_lshlrev_b32 v26, 16, v48
    v_and_b32 v27, 0xffff0000, v48
    v_lshlrev_b32 v42, 16, v42
    v_lshlrev_b32 v43, 16, v43
    v_pk_add_f32 v[26:27], v[26:27], v[42:43]
    v_cvt_pk_bf16_f32 v37, v26, v27
    v_cvt_pk_bf16_f32 v48, v28, v29
    v_lshlrev_b32 v28, 16, v48
    v_and_b32 v29, 0xffff0000, v48
    v_lshlrev_b32 v44, 16, v44
    v_lshlrev_b32 v45, 16, v45
    v_pk_add_f32 v[28:29], v[28:29], v[44:45]
    v_cvt_pk_bf16_f32 v38, v28, v29
    v_cvt_pk_bf16_f32 v48, v30, v31
    v_lshlrev_b32 v30, 16, v48
    v_and_b32 v31, 0xffff0000, v48
    v_lshlrev_b32 v46, 16, v46
    v_lshlrev_b32 v47, 16, v47
    v_pk_add_f32 v[30:31], v[30:31], v[46:47]
    v_cvt_pk_bf16_f32 v39, v30, v31
    s_cmp_eq_u32 s42, 0
    s_cbranch_scc1 oproj_mid
    v_lshlrev_b32 v10, 10, v6
    v_lshl_add_u32 v10, v2, 3, v10
    s_lshl_b32 s18, s13, 17
    s_lshl_b32 s19, s12, 6
    s_add_u32 s18, s18, s19
    buffer_store_dwordx2 v[32:33], v10, s[24:27], s18 offen offset:0
    buffer_store_dwordx2 v[34:35], v10, s[24:27], s18 offen offset:16
    buffer_store_dwordx2 v[36:37], v10, s[24:27], s18 offen offset:32
    buffer_store_dwordx2 v[38:39], v10, s[24:27], s18 offen offset:48
    s_endpgm
oproj_mid:
    v_lshlrev_b32 v48, 16, v32
    v_and_b32 v49, 0xffff0000, v32
    v_add_f32 v50, v50, v48
    v_fmac_f32 v51, v48, v48
    v_add_f32 v50, v50, v49
    v_fmac_f32 v51, v49, v49
    s_add_u32 s18, s17, 0
    s_add_u32 s19, s17, 4096
    buffer_store_short v32, v9, s[8:11], s18 offen
    buffer_store_short_d16_hi v32, v9, s[8:11], s19 offen
    v_lshlrev_b32 v48, 16, v33
    v_and_b32 v49, 0xffff0000, v33
    v_add_f32 v50, v50, v48
    v_fmac_f32 v51, v48, v48
    v_add_f32 v50, v50, v49
    v_fmac_f32 v51, v49, v49
    s_add_u32 s18, s17, 8192
    s_add_u32 s19, s17, 12288
    buffer_store_short v33, v9, s[8:11], s18 offen
    buffer_store_short_d16_hi v33, v9, s[8:11], s19 offen
    v_lshlrev_b32 v48, 16, v34
    v_and_b32 v49, 0xffff0000, v34
    v_add_f32 v50, v50, v48
    v_fmac_f32 v51, v48, v48
    v_add_f32 v50, v50, v49
    v_fmac_f32 v51, v49, v49
    s_add_u32 s18, s17, 32768
    s_add_u32 s19, s17, 36864
    buffer_store_short v34, v9, s[8:11], s18 offen
    buffer_store_short_d16_hi v34, v9, s[8:11], s19 offen
    v_lshlrev_b32 v48, 16, v35
    v_and_b32 v49, 0xffff0000, v35
    v_add_f32 v50, v50, v48
    v_fmac_f32 v51, v48, v48
    v_add_f32 v50, v50, v49
    v_fmac_f32 v51, v49, v49
    s_add_u32 s18, s17, 40960
    s_add_u32 s19, s17, 45056
    buffer_store_short v35, v9, s[8:11], s18 offen
    buffer_store_short_d16_hi v35, v9, s[8:11], s19 offen
    v_lshlrev_b32 v48, 16, v36
    v_and_b32 v49, 0xffff0000, v36
    v_add_f32 v50, v50, v48
    v_fmac_f32 v51, v48, v48
    v_add_f32 v50, v50, v49
    v_fmac_f32 v51, v49, v49
    s_add_u32 s18, s17, 65536
    s_add_u32 s19, s17, 69632
    buffer_store_short v36, v9, s[8:11], s18 offen
    buffer_store_short_d16_hi v36, v9, s[8:11], s19 offen
    v_lshlrev_b32 v48, 16, v37
    v_and_b32 v49, 0xffff0000, v37
    v_add_f32 v50, v50, v48
    v_fmac_f32 v51, v48, v48
    v_add_f32 v50, v50, v49
    v_fmac_f32 v51, v49, v49
    s_add_u32 s18, s17, 73728
    s_add_u32 s19, s17, 77824
    buffer_store_short v37, v9, s[8:11], s18 offen
    buffer_store_short_d16_hi v37, v9, s[8:11], s19 offen
    v_lshlrev_b32 v48, 16, v38
    v_and_b32 v49, 0xffff0000, v38
    v_add_f32 v50, v50, v48
    v_fmac_f32 v51, v48, v48
    v_add_f32 v50, v50, v49
    v_fmac_f32 v51, v49, v49
    s_add_u32 s18, s17, 98304
    s_add_u32 s19, s17, 102400
    buffer_store_short v38, v9, s[8:11], s18 offen
    buffer_store_short_d16_hi v38, v9, s[8:11], s19 offen
    v_lshlrev_b32 v48, 16, v39
    v_and_b32 v49, 0xffff0000, v39
    v_add_f32 v50, v50, v48
    v_fmac_f32 v51, v48, v48
    v_add_f32 v50, v50, v49
    v_fmac_f32 v51, v49, v49
    s_add_u32 s18, s17, 106496
    s_add_u32 s19, s17, 110592
    buffer_store_short v39, v9, s[8:11], s18 offen
    buffer_store_short_d16_hi v39, v9, s[8:11], s19 offen
    v_mov_b32 v52, v50
    v_mov_b32 v53, v51
    s_nop 1
    v_permlane32_swap_b32 v50, v52
    v_permlane32_swap_b32 v51, v53
    v_add_f32 v50, v50, v52
    v_add_f32 v51, v51, v53
    v_cmp_eq_u32 vcc, 1, v2
    s_nop 1
    v_cndmask_b32 v50, v50, v51, vcc
    v_lshlrev_b32 v10, 3, v6
    v_lshl_add_u32 v10, v2, 2, v10
    s_lshl_b32 s18, s13, 10
    s_add_u32 s18, s18, 25231360
    buffer_atomic_add_f32 v50, v10, s[8:11], s18 offen
oproj1_kernel_end:
    s_endpgm
.section .rodata,"a"
.p2align 6
.amdhsa_kernel prep_kernel
  .amdhsa_next_free_vgpr 96
  .amdhsa_next_free_sgpr 96
  .amdhsa_accum_offset 96
  .amdhsa_group_segment_fixed_size 0
  .amdhsa_kernarg_size 120
  .amdhsa_user_sgpr_count 2
  .amdhsa_user_sgpr_kernarg_segment_ptr 1
  .amdhsa_system_sgpr_workgroup_id_x 1
.end_amdhsa_kernel
.p2align 6
.amdhsa_kernel conv1_kernel
  .amdhsa_next_free_vgpr 232
  .amdhsa_next_free_sgpr 96
  .amdhsa_accum_offset 232
  .amdhsa_group_segment_fixed_size 0
  .amdhsa_kernarg_size 120
  .amdhsa_user_sgpr_count 2
  .amdhsa_user_sgpr_kernarg_segment_ptr 1
  .amdhsa_system_sgpr_workgroup_id_x 1
.end_amdhsa_kernel
.p2align 6
.amdhsa_kernel conv2_kernel
  .amdhsa_next_free_vgpr 232
  .amdhsa_next_free_sgpr 96
  .amdhsa_accum_offset 232
  .amdhsa_group_segment_fixed_size 0
  .amdhsa_kernarg_size 120
  .amdhsa_user_sgpr_count 2
  .amdhsa_user_sgpr_kernarg_segment_ptr 1
  .amdhsa_system_sgpr_workgroup_id_x 1
.end_amdhsa_kernel
.p2align 6
.amdhsa_kernel qkv1_kernel
  .amdhsa_next_free_vgpr 448
  .amdhsa_next_free_sgpr 96
  .amdhsa_accum_offset 256
  .amdhsa_group_segment_fixed_size 0
  .amdhsa_kernarg_size 120
  .amdhsa_user_sgpr_count 2
  .amdhsa_user_sgpr_kernarg_segment_ptr 1
  .amdhsa_system_sgpr_workgroup_id_x 1
.end_amdhsa_kernel
.p2align 6
.amdhsa_kernel qkv2_kernel
  .amdhsa_next_free_vgpr 448
  .amdhsa_next_free_sgpr 96
  .amdhsa_accum_offset 256
  .amdhsa_group_segment_fixed_size 0
  .amdhsa_kernarg_size 120
  .amdhsa_user_sgpr_count 2
  .amdhsa_user_sgpr_kernarg_segment_ptr 1
  .amdhsa_system_sgpr_workgroup_id_x 1
.end_amdhsa_kernel
.p2align 6
.amdhsa_kernel attn1_kernel
  .amdhsa_next_free_vgpr 256
  .amdhsa_next_free_sgpr 96
  .amdhsa_accum_offset 256
  .amdhsa_group_segment_fixed_size 0
  .amdhsa_kernarg_size 120
  .amdhsa_user_sgpr_count 2
  .amdhsa_user_sgpr_kernarg_segment_ptr 1
  .amdhsa_system_sgpr_workgroup_id_x 1
.end_amdhsa_kernel
.p2align 6
.amdhsa_kernel oproj1_kernel
  .amdhsa_next_free_vgpr 352
  .amdhsa_next_free_sgpr 96
  .amdhsa_accum_offset 224
  .amdhsa_group_segment_fixed_size 0
  .amdhsa_kernarg_size 120
  .amdhsa_user_sgpr_count 2
  .amdhsa_user_sgpr_kernarg_segment_ptr 1
  .amdhsa_system_sgpr_workgroup_id_x 1
.end_amdhsa_kernel
.p2align 6
.amdhsa_kernel oproj2_kernel
  .amdhsa_next_free_vgpr 352
  .amdhsa_next_free_sgpr 96
  .amdhsa_accum_offset 224
  .amdhsa_group_segment_fixed_size 0
  .amdhsa_kernarg_size 120
  .amdhsa_user_sgpr_count 2
  .amdhsa_user_sgpr_kernarg_segment_ptr 1
  .amdhsa_system_sgpr_workgroup_id_x 1
.end_amdhsa_kernel
```
